```python
import torch

def _softmax(x, axis=-1):
    return torch.softmax(x, dim=axis)
def _gelu(x):
    return torch.nn.functional.gelu(x, approximate="tanh")
def _silu(x):
    return torch.nn.functional.silu(x)
def _sigmoid(x):
    return torch.sigmoid(x)
def _layernorm(x, axis=-1, eps=1e-5):
    m = x.mean(dim=axis, keepdim=True)
    v = x.var(dim=axis, keepdim=True, unbiased=False)
    return (x - m) / torch.sqrt(v + eps)
def _scatter_add(tgt, idx, src, axis=0):
    return tgt.clone().index_add_(axis, idx, src)
def _segment_sum(src, seg, n):
    out = torch.zeros((n,) + src.shape[1:], dtype=src.dtype)
    return out.index_add_(0, seg, src)
def _pad(x, pw):
    flat = tuple(v for pair in reversed(pw) for v in pair)
    return torch.nn.functional.pad(x, flat)

kernel_name = 'gather_scatter__cheap_equivariant_egnn__graph'

def setup_inputs():

    _w = (lambda a: (lambda t: t.to(torch.bfloat16) if t.is_floating_point() else t)(torch.as_tensor(a)))
    N, deg, D, De = 12500, 64, 64, max(0, 1)
    E = N * deg
    return {
        "h": _w((lambda *s: torch.randn(*s, dtype=torch.bfloat16) * 0.1)(N, D)),
        "pos": _w((lambda *s: torch.randn(*s, dtype=torch.bfloat16) * 0.8)(N, 3)),
        "e_attr": _w((lambda *s: torch.randn(*s, dtype=torch.bfloat16) * 0.8)(E, De)),
        "src": _w((lambda lo, hi, *s: torch.randint(lo, hi, s))(0, N, E).to(torch.int64)),
        "dst": _w((lambda lo, hi, *s: torch.randint(lo, hi, s))(0, N, E).to(torch.int64)),
        "w_e": _w(0.1 * (lambda *s: torch.randn(*s, dtype=torch.bfloat16) * 0.8)(2 * D + 1 + De, D)),
        "w_x": _w(0.1 * (lambda *s: torch.randn(*s, dtype=torch.bfloat16) * 0.1)(D, 1)),
        "w_h": _w(0.1 * (lambda *s: torch.randn(*s, dtype=torch.bfloat16) * 0.1)(2 * D, D)),
    }

def reference(h, pos, e_attr, src, dst, w_e, w_x, w_h):
    N, D = h.shape[0], h.shape[1]
    diff = pos[dst] - pos[src]
    dist2 = torch.sum(diff * diff, axis=-1, keepdims=True)
    e_in = torch.concatenate([h[dst], h[src], dist2, e_attr], axis=-1)
    m_ij = _silu(e_in @ w_e)
    coord_scale = m_ij @ w_x
    pos_new = pos + _segment_sum(diff * coord_scale, dst, N)
    m_i = _segment_sum(m_ij, dst, N)
    h_new = h + _silu(torch.concatenate([h, m_i], axis=-1) @ w_h)
    return h_new, pos_new
```

```asm
; @launch grid=(256,1,1) block=(512,1,1) lds=162688
.amdgcn_target "amdgcn-amd-amdhsa--gfx950"
.text
.globl gather_scatter__cheap_equivariant_egnn__graph_kernel
.p2align 8
.type gather_scatter__cheap_equivariant_egnn__graph_kernel,@function
gather_scatter__cheap_equivariant_egnn__graph_kernel:
    s_cmp_ge_u32 s2, 256
    s_cbranch_scc1 K2_END
    s_load_dwordx2 s[12:13], s[0:1], 80
    v_readfirstlane_b32 s3, v0
    v_and_b32 v6, 63, v0
    s_mov_b32 s14, 33554432
    s_mov_b32 s15, 0x00020000
    s_lshr_b32 s3, s3, 6
    v_lshlrev_b32 v7, 4, v6
    s_mov_b32 s43, s2
    s_cmp_ge_u32 s3, 4
    s_cbranch_scc1 K1_TW
    s_load_dwordx2 s[8:9], s[0:1], 32
    s_load_dwordx2 s[16:17], s[0:1], 24
    s_load_dwordx2 s[4:5], s[0:1], 16
    s_load_dwordx2 s[84:85], s[0:1], 40
    s_load_dwordx2 s[88:89], s[0:1], 48
    s_mov_b32 s86, 16640
    s_mov_b32 s87, 0x00020000
    s_mov_b32 s90, 128
    s_mov_b32 s91, 0x00020000
    v_and_b32 v107, 31, v6
    v_lshlrev_b32 v107, 1, v107
    s_movk_i32 s93, 16384
    v_lshlrev_b32 v2, 2, v0
    v_mov_b32 v176, 0
    ds_write_b32 v2, v176 offset:4096
    s_mov_b32 s10, 3200000
    s_mov_b32 s11, 0x00020000
    s_mov_b64 s[18:19], s[10:11]
    s_mov_b32 s6, 1600000
    s_mov_b32 s7, 0x00020000
    s_mul_i32 s44, s2, 3136
    s_mul_i32 s45, s3, 784
    s_add_u32 s44, s44, s45
    s_lshl_b32 s46, s44, 2
    s_lshl_b32 s47, s44, 1
    s_sub_i32 s45, 800000, s44
    v_lshlrev_b32 v2, 2, v6
    v_lshlrev_b32 v5, 3, v6
    v_lshlrev_b32 v3, 1, v6
    s_waitcnt lgkmcnt(0)
    buffer_load_dwordx4 v[8:11], v7, s[8:11], s46 offen offset:0
    buffer_load_dwordx4 v[12:15], v7, s[8:11], s46 offen offset:1024
    buffer_load_dwordx4 v[16:19], v7, s[8:11], s46 offen offset:2048
    buffer_load_dword v20, v2, s[8:11], s46 offen offset:3072
    s_lshr_b32 s54, s2, 3
    s_and_b32 s2, s2, 7
    s_lshl_b32 s2, s2, 5
    s_add_u32 s2, s2, s54
    s_add_u32 s62, s12, 4587520
    s_addc_u32 s63, s13, 0
    s_load_dwordx2 s[70:71], s[62:63], 0
    s_load_dwordx2 s[20:21], s[0:1], 64
    v_cmp_gt_i32 s[76:77], s45, v2
    s_sub_i32 s48, s45, 256
    v_cmp_gt_i32 s[78:79], s48, v2
    s_sub_i32 s48, s45, 512
    v_cmp_gt_i32 s[80:81], s48, v2
    s_sub_i32 s48, s45, 768
    s_min_i32 s48, s48, 16
    v_cmp_gt_i32 s[82:83], s48, v6
    s_movk_i32 s50, -49
    v_mov_b32 v4, 1
    s_barrier
    v_mov_b32 v177, 0
    v_mov_b32 v178, 0
    v_mov_b32 v179, 0
    s_lshl_b32 s48, s3, 12
    s_add_u32 s48, s48, 97152
    v_add_u32 v106, s48, v7
    ds_write_b128 v106, v[176:179] offset:0
    ds_write_b128 v106, v[176:179] offset:1024
    ds_write_b128 v106, v[176:179] offset:2048
    ds_write_b128 v106, v[176:179] offset:3072
    s_barrier
    buffer_load_dwordx4 v[24:27], v7, s[16:19], s46 offen offset:0
    buffer_load_dwordx2 v[40:41], v5, s[4:7], s47 offen offset:0
    buffer_load_dwordx4 v[28:31], v7, s[16:19], s46 offen offset:1024
    buffer_load_dwordx2 v[42:43], v5, s[4:7], s47 offen offset:512
    buffer_load_dwordx4 v[32:35], v7, s[16:19], s46 offen offset:2048
    buffer_load_dwordx2 v[44:45], v5, s[4:7], s47 offen offset:1024
    buffer_load_dword v36, v2, s[16:19], s46 offen offset:3072
    buffer_load_ushort v46, v3, s[4:7], s47 offen offset:1536
    s_mov_b64 exec, s[76:77]
    s_waitcnt vmcnt(11)
    v_mul_u32_u24 v48, 21400, v8
    v_lshrrev_b32 v48, 20, v48
    v_mad_i32_i24 v8, v48, s50, v8
    v_lshlrev_b32 v48, 2, v48
    ds_add_rtn_u32 v64, v48, v4 offset:4096
    v_mul_u32_u24 v49, 21400, v9
    v_lshrrev_b32 v49, 20, v49
    v_mad_i32_i24 v9, v49, s50, v9
    v_lshlrev_b32 v49, 2, v49
    ds_add_rtn_u32 v65, v49, v4 offset:4096
    v_mul_u32_u24 v50, 21400, v10
    v_lshrrev_b32 v50, 20, v50
    v_mad_i32_i24 v10, v50, s50, v10
    v_lshlrev_b32 v50, 2, v50
    ds_add_rtn_u32 v66, v50, v4 offset:4096
    v_mul_u32_u24 v51, 21400, v11
    v_lshrrev_b32 v51, 20, v51
    v_mad_i32_i24 v11, v51, s50, v11
    v_lshlrev_b32 v51, 2, v51
    ds_add_rtn_u32 v67, v51, v4 offset:4096
    s_mov_b64 exec, s[78:79]
    s_waitcnt vmcnt(10)
    v_mul_u32_u24 v52, 21400, v12
    v_lshrrev_b32 v52, 20, v52
    v_mad_i32_i24 v12, v52, s50, v12
    v_lshlrev_b32 v52, 2, v52
    ds_add_rtn_u32 v68, v52, v4 offset:4096
    v_mul_u32_u24 v53, 21400, v13
    v_lshrrev_b32 v53, 20, v53
    v_mad_i32_i24 v13, v53, s50, v13
    v_lshlrev_b32 v53, 2, v53
    ds_add_rtn_u32 v69, v53, v4 offset:4096
    v_mul_u32_u24 v54, 21400, v14
    v_lshrrev_b32 v54, 20, v54
    v_mad_i32_i24 v14, v54, s50, v14
    v_lshlrev_b32 v54, 2, v54
    ds_add_rtn_u32 v70, v54, v4 offset:4096
    v_mul_u32_u24 v55, 21400, v15
    v_lshrrev_b32 v55, 20, v55
    v_mad_i32_i24 v15, v55, s50, v15
    v_lshlrev_b32 v55, 2, v55
    ds_add_rtn_u32 v71, v55, v4 offset:4096
    s_mov_b64 exec, s[80:81]
    s_waitcnt vmcnt(9)
    v_mul_u32_u24 v56, 21400, v16
    v_lshrrev_b32 v56, 20, v56
    v_mad_i32_i24 v16, v56, s50, v16
    v_lshlrev_b32 v56, 2, v56
    ds_add_rtn_u32 v72, v56, v4 offset:4096
    v_mul_u32_u24 v57, 21400, v17
    v_lshrrev_b32 v57, 20, v57
    v_mad_i32_i24 v17, v57, s50, v17
    v_lshlrev_b32 v57, 2, v57
    ds_add_rtn_u32 v73, v57, v4 offset:4096
    v_mul_u32_u24 v58, 21400, v18
    v_lshrrev_b32 v58, 20, v58
    v_mad_i32_i24 v18, v58, s50, v18
    v_lshlrev_b32 v58, 2, v58
    ds_add_rtn_u32 v74, v58, v4 offset:4096
    v_mul_u32_u24 v59, 21400, v19
    v_lshrrev_b32 v59, 20, v59
    v_mad_i32_i24 v19, v59, s50, v19
    v_lshlrev_b32 v59, 2, v59
    ds_add_rtn_u32 v75, v59, v4 offset:4096
    s_mov_b64 exec, s[82:83]
    s_waitcnt vmcnt(8)
    v_mul_u32_u24 v60, 21400, v20
    v_lshrrev_b32 v60, 20, v60
    v_mad_i32_i24 v20, v60, s50, v20
    v_lshlrev_b32 v60, 2, v60
    ds_add_rtn_u32 v76, v60, v4 offset:4096
    s_mov_b64 exec, -1
    s_mov_b32 s51, 0xffff0000
    s_waitcnt lgkmcnt(0)
    s_barrier
    buffer_load_ushort v126, v107, s[84:87], s93 offen
    buffer_load_ushort v127, v107, s[84:87], s93 offen offset:128
    buffer_load_ushort v128, v107, s[84:87], s93 offen offset:64
    buffer_load_ushort v129, v107, s[84:87], s93 offen offset:192
    buffer_load_ushort v180, v107, s[88:91], 0 offen
    buffer_load_ushort v182, v107, s[88:91], 0 offen offset:64
    ds_read_b128 v[96:99], v7 offset:4096
    s_waitcnt lgkmcnt(0)
    v_add_u32 v97, v96, v97
    v_add_u32 v98, v97, v98
    v_add_u32 v99, v98, v99
    v_mov_b32 v100, v99
    s_nop 1
    v_add_u32_dpp v100, v100, v100 row_shr:1 row_mask:0xf bank_mask:0xf bound_ctrl:0
    s_nop 1
    v_add_u32_dpp v100, v100, v100 row_shr:2 row_mask:0xf bank_mask:0xf bound_ctrl:0
    s_nop 1
    v_add_u32_dpp v100, v100, v100 row_shr:4 row_mask:0xf bank_mask:0xf bound_ctrl:0
    s_nop 1
    v_add_u32_dpp v100, v100, v100 row_shr:8 row_mask:0xf bank_mask:0xf bound_ctrl:0
    s_nop 1
    v_add_u32_dpp v100, v100, v100 row_bcast:15 row_mask:0xa bank_mask:0xf
    s_nop 1
    v_add_u32_dpp v100, v100, v100 row_bcast:31 row_mask:0xc bank_mask:0xf
    v_sub_u32 v102, v100, v99
    v_add_u32 v103, v102, v96
    v_add_u32 v104, v102, v97
    v_add_u32 v105, v102, v98
    ds_write_b128 v7, v[102:105] offset:5120
    ds_read_b32 v80, v48 offset:5120
    ds_read_b32 v81, v49 offset:5120
    ds_read_b32 v82, v50 offset:5120
    ds_read_b32 v83, v51 offset:5120
    ds_read_b32 v84, v52 offset:5120
    ds_read_b32 v85, v53 offset:5120
    ds_read_b32 v86, v54 offset:5120
    ds_read_b32 v87, v55 offset:5120
    ds_read_b32 v88, v56 offset:5120
    ds_read_b32 v89, v57 offset:5120
    ds_read_b32 v90, v58 offset:5120
    ds_read_b32 v91, v59 offset:5120
    ds_read_b32 v92, v60 offset:5120
    s_waitcnt lgkmcnt(0)
    s_mov_b64 exec, s[76:77]
    v_add_u32 v80, v80, v64
    ds_write_b8 v80, v8 offset:18688
    v_lshlrev_b32 v64, 2, v80
    v_add_u32 v81, v81, v65
    ds_write_b8 v81, v9 offset:18688
    v_lshlrev_b32 v65, 2, v81
    v_add_u32 v82, v82, v66
    ds_write_b8 v82, v10 offset:18688
    v_lshlrev_b32 v66, 2, v82
    v_add_u32 v83, v83, v67
    ds_write_b8 v83, v11 offset:18688
    v_lshlrev_b32 v67, 2, v83
    s_mov_b64 exec, s[78:79]
    v_add_u32 v84, v84, v68
    ds_write_b8 v84, v12 offset:18688
    v_lshlrev_b32 v68, 2, v84
    v_add_u32 v85, v85, v69
    ds_write_b8 v85, v13 offset:18688
    v_lshlrev_b32 v69, 2, v85
    v_add_u32 v86, v86, v70
    ds_write_b8 v86, v14 offset:18688
    v_lshlrev_b32 v70, 2, v86
    v_add_u32 v87, v87, v71
    ds_write_b8 v87, v15 offset:18688
    v_lshlrev_b32 v71, 2, v87
    s_mov_b64 exec, s[80:81]
    v_add_u32 v88, v88, v72
    ds_write_b8 v88, v16 offset:18688
    v_lshlrev_b32 v72, 2, v88
    v_add_u32 v89, v89, v73
    ds_write_b8 v89, v17 offset:18688
    v_lshlrev_b32 v73, 2, v89
    v_add_u32 v90, v90, v74
    ds_write_b8 v90, v18 offset:18688
    v_lshlrev_b32 v74, 2, v90
    v_add_u32 v91, v91, v75
    ds_write_b8 v91, v19 offset:18688
    v_lshlrev_b32 v75, 2, v91
    s_mov_b64 exec, s[82:83]
    v_add_u32 v92, v92, v76
    ds_write_b8 v92, v20 offset:18688
    v_lshlrev_b32 v76, 2, v92
    s_mov_b64 exec, s[76:77]
    s_waitcnt vmcnt(12)
    v_lshl_or_b32 v24, v40, 16, v24
    ds_write_b32 v64, v24 offset:6144
    v_and_or_b32 v25, v40, s51, v25
    ds_write_b32 v65, v25 offset:6144
    v_lshl_or_b32 v26, v41, 16, v26
    ds_write_b32 v66, v26 offset:6144
    v_and_or_b32 v27, v41, s51, v27
    ds_write_b32 v67, v27 offset:6144
    s_mov_b64 exec, s[78:79]
    s_waitcnt vmcnt(10)
    v_lshl_or_b32 v28, v42, 16, v28
    ds_write_b32 v68, v28 offset:6144
    v_and_or_b32 v29, v42, s51, v29
    ds_write_b32 v69, v29 offset:6144
    v_lshl_or_b32 v30, v43, 16, v30
    ds_write_b32 v70, v30 offset:6144
    v_and_or_b32 v31, v43, s51, v31
    ds_write_b32 v71, v31 offset:6144
    s_mov_b64 exec, s[80:81]
    s_waitcnt vmcnt(8)
    v_lshl_or_b32 v32, v44, 16, v32
    ds_write_b32 v72, v32 offset:6144
    v_and_or_b32 v33, v44, s51, v33
    ds_write_b32 v73, v33 offset:6144
    v_lshl_or_b32 v34, v45, 16, v34
    ds_write_b32 v74, v34 offset:6144
    v_and_or_b32 v35, v45, s51, v35
    ds_write_b32 v75, v35 offset:6144
    s_mov_b64 exec, s[82:83]
    s_waitcnt vmcnt(6)
    v_lshl_or_b32 v36, v46, 16, v36
    ds_write_b32 v76, v36 offset:6144
    s_mov_b64 exec, -1
    v_lshlrev_b32 v4, 4, v0
    v_cmp_gt_u32 vcc, 468, v0
    s_mul_i32 s49, s43, 15744
    s_add_u32 s48, s49, 8192
    s_waitcnt lgkmcnt(0)
    s_barrier
    ds_read_b128 v[108:111], v4 offset:6144
    ds_read_b128 v[190:193], v4 offset:14336
    s_waitcnt lgkmcnt(1)
    buffer_store_dwordx4 v[108:111], v4, s[12:15], s49 offen sc1
    s_and_b64 exec, exec, vcc
    s_cbranch_execz K1_COE
    s_waitcnt lgkmcnt(0)
    buffer_store_dwordx4 v[190:193], v4, s[12:15], s48 offen sc1
K1_COE:
    s_mov_b64 exec, -1
    v_mov_b32 v8, v6
    v_lshrrev_b32 v9, 5, v8
    v_and_b32 v10, 31, v8
    v_bfe_u32 v11, v8, 2, 2
    v_and_b32 v12, 3, v8
    v_bfe_u32 v13, v8, 4, 1
    v_lshrrev_b32 v14, 3, v8
    v_lshlrev_b32 v229, 5, v14
    v_and_b32 v14, 7, v8
    v_lshlrev_b32 v15, 2, v13
    v_xor_b32 v14, v14, v15
    v_lshlrev_b32 v216, 4, v14
    v_lshl_add_u32 v14, v9, 3, v11
    v_lshlrev_b32 v14, 7, v14
    v_lshl_add_u32 v14, v13, 5, v14
    v_lshl_add_u32 v14, v12, 3, v14
    v_add_u32 v14, 129920, v14
    v_lshrrev_b32 v15, 1, v11
    v_lshl_add_u32 v220, v15, 6, v14
    v_xor_b32 v15, 1, v15
    v_lshl_add_u32 v221, v15, 6, v14
    v_lshlrev_b32 v228, 7, v10
    v_add_u32 v228, 97152, v228
    v_and_b32 v14, 1, v8
    v_lshl_or_b32 v14, v11, 1, v14
    v_lshl_add_u32 v228, v14, 4, v228
    v_bfe_u32 v14, v8, 1, 1
    v_xor_b32 v14, v14, v9
    v_lshl_add_u32 v228, v14, 3, v228
    v_lshl_add_u32 v12, v13, 2, v12
    v_and_b32 v14, 1, v11
    v_lshl_or_b32 v14, v9, 1, v14
    v_xor_b32 v14, v14, v12
    v_lshrrev_b32 v15, 1, v11
    v_lshl_add_u32 v11, v9, 2, v11
    v_lshlrev_b32 v240, 7, v11
    v_lshl_add_u32 v224, v15, 3, v240
    v_add_u32 v224, 97152, v224
    v_xor_b32 v15, 4, v14
    v_lshl_add_u32 v225, v15, 4, v224
    v_add_u32 v225, 1024, v225
    v_lshl_add_u32 v224, v14, 4, v224
    v_xor_b32 v226, 8, v224
    v_xor_b32 v227, 8, v225
    v_mul_u32_u24 v240, 144, v11
    v_lshl_add_u32 v240, v12, 3, v240
    v_add_u32 v240, 37376, v240
    v_mul_u32_u24 v230, 528, v9
    v_lshl_add_u32 v230, v10, 3, v230
    v_add_u32 v230, 71168, v230
    v_bfe_u32 v14, v8, 3, 2
    v_lshl_add_u32 v14, v14, 1, v9
    v_lshlrev_b32 v231, 5, v14
    v_and_b32 v14, 4, v8
    v_lshl_add_u32 v231, v14, 1, v231
    v_and_b32 v14, 1, v8
    v_lshl_add_u32 v231, v14, 4, v231
    v_lshlrev_b32 v241, 3, v8
    v_lshlrev_b32 v14, 4, v14
    v_mov_b32 v243, 0x3f80
    v_lshlrev_b32 v243, v14, v243
    v_lshrrev_b32 v14, 1, v8
    v_lshlrev_b32 v14, 2, v14
    v_lshl_add_u32 v242, v8, 4, v14
    v_and_b32 v14, 3, v8
    v_bfe_u32 v15, v8, 2, 3
    v_lshl_add_u32 v14, v14, 3, v15
    v_and_b32 v15, 3, v14
    v_xor_b32 v236, 1, v15
    v_lshl_or_b32 v236, v236, 2, v15
    v_mul_u32_u24 v236, 0x1111, v236
    v_lshrrev_b32 v14, 2, v14
    v_lshlrev_b32 v15, 2, v9
    v_sub_u32 v14, v14, v15
    v_mov_b32 v15, 0x3f80
    v_cmp_eq_u32 s[76:77], 0, v14
    v_cmp_eq_u32 s[78:79], 1, v14
    v_cmp_eq_u32 s[80:81], 2, v14
    v_cmp_eq_u32 s[82:83], 3, v14
    v_cndmask_b32 v232, 0, v15, s[76:77]
    v_cndmask_b32 v233, 0, v15, s[78:79]
    v_cndmask_b32 v234, 0, v15, s[80:81]
    v_cndmask_b32 v235, 0, v15, s[82:83]
    v_and_b32 v14, 15, v8
    v_lshrrev_b32 v15, 4, v8
    v_mul_u32_u24 v244, 528, v14
    v_lshl_add_u32 v244, v15, 6, v244
    v_add_u32 v244, 71168, v244
    v_lshlrev_b32 v247, 7, v14
    v_bfe_u32 v14, v8, 1, 3
    v_xor_b32 v14, v14, v15
    v_lshl_add_u32 v245, v14, 4, v247
    v_add_u32 v245, 46592, v245
    v_xor_b32 v246, 64, v245
    v_lshl_add_u32 v247, v15, 4, v247
    s_lshl_b32 s44, s3, 12
    s_and_b32 s45, s3, 3
    s_mul_i32 s46, s45, 8448
    s_lshl_b32 s45, s45, 11
    v_add_u32 v220, s44, v220
    v_add_u32 v221, s44, v221
    v_add_u32 v224, s44, v224
    v_add_u32 v225, s44, v225
    v_add_u32 v226, s44, v226
    v_add_u32 v227, s44, v227
    v_add_u32 v228, s44, v228
    v_add_u32 v244, s46, v244
    v_add_u32 v245, s45, v245
    v_add_u32 v246, s45, v246
    s_branch K1_JOIN
K1_TW:
    s_load_dwordx2 s[8:9], s[0:1], 40
    s_load_dwordx2 s[24:25], s[0:1], 0
    s_load_dwordx2 s[16:17], s[0:1], 8
    s_load_dwordx2 s[4:5], s[0:1], 56
    s_load_dwordx2 s[84:85], s[0:1], 40
    s_load_dwordx2 s[88:89], s[0:1], 48
    s_mov_b32 s86, 16640
    s_mov_b32 s87, 0x00020000
    s_mov_b32 s90, 128
    s_mov_b32 s91, 0x00020000
    v_and_b32 v107, 31, v6
    v_lshlrev_b32 v107, 1, v107
    s_movk_i32 s93, 16384
    s_mov_b32 s10, 16640
    s_mov_b32 s11, 0x00020000
    s_mov_b32 s26, 1600000
    s_mov_b32 s27, 0x00020000
    s_mov_b32 s6, 16384
    s_mov_b32 s7, 0x00020000
    s_and_b32 s61, s3, 1
    s_bfe_u32 s60, s3, 0x10001
    s_lshl_b32 s57, s3, 13
    s_add_u32 s57, s57, 97152
    v_and_b32 v9, 48, v6
    v_xor_b32 v9, v9, v7
    v_xor_b32 v10, 64, v9
    v_lshrrev_b32 v11, 2, v6
    v_and_b32 v12, 3, v6
    v_lshlrev_b32 v12, 4, v12
    v_lshl_add_u32 v11, v11, 7, v12
    v_mov_b32 v176, 0
    v_mov_b32 v177, 0
    v_mov_b32 v178, 0
    v_mov_b32 v179, 0
    v_lshlrev_b32 v13, 2, v6
    ds_write_b32 v13, v176 offset:28672
    s_waitcnt lgkmcnt(0)
    s_lshr_b32 s54, s2, 3
    s_and_b32 s2, s2, 7
    s_lshl_b32 s2, s2, 5
    s_add_u32 s2, s2, s54
    s_add_u32 s62, s12, 4587520
    s_addc_u32 s63, s13, 0
    s_load_dwordx2 s[70:71], s[62:63], 0
    s_load_dwordx2 s[20:21], s[0:1], 64
    s_mul_i32 s28, s2, 49
    s_lshl_b32 s56, s60, 5
    s_add_u32 s56, s56, s28
    s_lshl_b32 s56, s56, 7
    s_lshl_b32 s58, s60, 12
    s_add_u32 m0, s58, 46592
    s_lshl_b32 s59, s61, 6
    s_add_u32 s55, s59, 8192
    s_barrier
    buffer_load_dwordx4 v9, s[24:27], s56 offen offset:0 lds
    buffer_load_dwordx4 v10, s[24:27], s56 offen offset:1024 lds
    buffer_load_dwordx4 v9, s[24:27], s56 offen offset:2048 lds
    buffer_load_dwordx4 v10, s[24:27], s56 offen offset:3072 lds
    s_mov_b32 m0, s57
    s_mov_b32 s18, 75000
    buffer_load_dwordx4 v11, s[8:11], s55 offen offset:0 lds
    s_add_u32 s55, s55, 1024
    buffer_load_dwordx4 v11, s[8:11], s55 offen offset:1024 lds
    s_add_u32 s55, s55, 1024
    buffer_load_dwordx4 v11, s[8:11], s55 offen offset:2048 lds
    s_add_u32 s55, s55, 1024
    buffer_load_dwordx4 v11, s[8:11], s55 offen offset:3072 lds
    s_mov_b32 s19, 0x00020000
    s_cmp_lg_u32 s3, 7
    s_cbranch_scc1 K1_NOP8
    v_add_u32 v100, s28, v6
    v_mul_u32_u24 v101, 6, v100
    buffer_load_ushort v102, v101, s[16:19], 0 offen
    buffer_load_ushort v104, v101, s[16:19], 0 offen offset:2
    buffer_load_ushort v103, v101, s[16:19], 0 offen offset:4
K1_NOP8:
    s_barrier
    v_lshlrev_b32 v106, 4, v0
    v_add_u32 v106, 67072, v106
    ds_write_b128 v106, v[176:179] offset:0
    ds_write_b128 v106, v[176:179] offset:4096
    ds_write_b128 v106, v[176:179] offset:8192
    ds_write_b128 v106, v[176:179] offset:12288
    ds_write_b128 v106, v[176:179] offset:16384
    ds_write_b128 v106, v[176:179] offset:20480
    v_cmp_gt_u32 vcc, 344, v0
    s_and_saveexec_b64 s[44:45], vcc
    ds_write_b128 v106, v[176:179] offset:24576
    s_mov_b64 exec, -1
    v_lshrrev_b32 v8, 5, v6
    v_and_b32 v9, 31, v6
    v_bfe_u32 v12, v6, 2, 2
    v_lshl_add_u32 v12, v8, 3, v12
    v_lshlrev_b32 v12, 6, v12
    v_bfe_u32 v13, v6, 4, 1
    v_lshl_add_u32 v12, v13, 5, v12
    v_and_b32 v13, 3, v6
    v_lshl_add_u32 v12, v13, 3, v12
    v_add_u32 v12, s57, v12
    v_bfe_u32 v10, v6, 1, 3
    v_xor_b32 v10, v10, v8
    s_lshl_b32 s58, s60, 12
    s_add_u32 s58, s58, 46592
    v_lshlrev_b32 v14, 7, v9
    v_add_u32 v14, s58, v14
    v_xor_b32 v96, 0, v10
    v_lshl_add_u32 v96, v96, 4, v14
    v_xor_b32 v97, 2, v10
    v_lshl_add_u32 v97, v97, 4, v14
    v_xor_b32 v98, 4, v10
    v_lshl_add_u32 v98, v98, 4, v14
    v_xor_b32 v99, 6, v10
    v_lshl_add_u32 v99, v99, 4, v14
    v_mul_u32_u24 v13, 80, v9
    v_lshl_add_u32 v13, v8, 3, v13
    v_add_u32 v13, s57, v13
    v_lshrrev_b32 v14, 2, v6
    v_mul_u32_u24 v15, 80, v14
    v_and_b32 v14, 3, v6
    v_lshl_add_u32 v15, v14, 4, v15
    v_add_u32 v15, s57, v15
    s_mov_b32 s55, 0xbfb8aa3b
    s_lshl_b32 s59, s61, 6
    s_add_u32 s56, s56, 4688000
    s_add_u32 s56, s56, s59
    s_waitcnt vmcnt(0)
    s_setprio 3
    ds_read_b128 v[16:19], v96
    ds_read_b64_tr_b16 v[32:33], v12 offset:0
    ds_read_b64_tr_b16 v[34:35], v12 offset:256
    ds_read_b128 v[20:23], v97
    ds_read_b64_tr_b16 v[36:37], v12 offset:1024
    ds_read_b64_tr_b16 v[38:39], v12 offset:1280
    ds_read_b128 v[24:27], v98
    ds_read_b64_tr_b16 v[40:41], v12 offset:2048
    ds_read_b64_tr_b16 v[42:43], v12 offset:2304
    ds_read_b128 v[28:31], v99
    ds_read_b64_tr_b16 v[44:45], v12 offset:3072
    ds_read_b64_tr_b16 v[46:47], v12 offset:3328
    s_waitcnt lgkmcnt(9)
    v_mfma_f32_32x32x16_bf16 v[64:79], v[32:35], v[16:19], 0
    s_waitcnt lgkmcnt(6)
    v_mfma_f32_32x32x16_bf16 v[64:79], v[36:39], v[20:23], v[64:79]
    s_waitcnt lgkmcnt(3)
    v_mfma_f32_32x32x16_bf16 v[64:79], v[40:43], v[24:27], v[64:79]
    s_waitcnt lgkmcnt(0)
    v_mfma_f32_32x32x16_bf16 v[64:79], v[44:47], v[28:31], v[64:79]
    s_nop 11
    v_mul_f32 v64, s55, v64
    v_mul_f32 v65, s55, v65
    v_mul_f32 v66, s55, v66
    v_mul_f32 v67, s55, v67
    v_and_b32 v105, 0x7fffffff, v64
    v_and_b32 v106, 0x7fffffff, v65
    v_max_u32 v105, v105, v106
    v_and_b32 v106, 0x7fffffff, v66
    v_max_u32 v105, v105, v106
    v_and_b32 v106, 0x7fffffff, v67
    v_max_u32 v105, v105, v106
    v_cvt_pk_bf16_f32 v64, v64, v65
    v_cvt_pk_bf16_f32 v65, v66, v67
    ds_write_b64 v13, v[64:65] offset:0
    v_mul_f32 v68, s55, v68
    v_mul_f32 v69, s55, v69
    v_mul_f32 v70, s55, v70
    v_mul_f32 v71, s55, v71
    v_and_b32 v106, 0x7fffffff, v68
    v_max_u32 v105, v105, v106
    v_and_b32 v106, 0x7fffffff, v69
    v_max_u32 v105, v105, v106
    v_and_b32 v106, 0x7fffffff, v70
    v_max_u32 v105, v105, v106
    v_and_b32 v106, 0x7fffffff, v71
    v_max_u32 v105, v105, v106
    v_cvt_pk_bf16_f32 v68, v68, v69
    v_cvt_pk_bf16_f32 v69, v70, v71
    ds_write_b64 v13, v[68:69] offset:16
    v_mul_f32 v72, s55, v72
    v_mul_f32 v73, s55, v73
    v_mul_f32 v74, s55, v74
    v_mul_f32 v75, s55, v75
    v_and_b32 v106, 0x7fffffff, v72
    v_max_u32 v105, v105, v106
    v_and_b32 v106, 0x7fffffff, v73
    v_max_u32 v105, v105, v106
    v_and_b32 v106, 0x7fffffff, v74
    v_max_u32 v105, v105, v106
    v_and_b32 v106, 0x7fffffff, v75
    v_max_u32 v105, v105, v106
    v_cvt_pk_bf16_f32 v72, v72, v73
    v_cvt_pk_bf16_f32 v73, v74, v75
    ds_write_b64 v13, v[72:73] offset:32
    v_mul_f32 v76, s55, v76
    v_mul_f32 v77, s55, v77
    v_mul_f32 v78, s55, v78
    v_mul_f32 v79, s55, v79
    v_and_b32 v106, 0x7fffffff, v76
    v_max_u32 v105, v105, v106
    v_and_b32 v106, 0x7fffffff, v77
    v_max_u32 v105, v105, v106
    v_and_b32 v106, 0x7fffffff, v78
    v_max_u32 v105, v105, v106
    v_and_b32 v106, 0x7fffffff, v79
    v_max_u32 v105, v105, v106
    v_cvt_pk_bf16_f32 v76, v76, v77
    v_cvt_pk_bf16_f32 v77, v78, v79
    ds_write_b64 v13, v[76:77] offset:48
    s_lshl_b32 s58, s60, 7
    v_lshl_add_u32 v106, v9, 2, s58
    ds_max_u32 v106, v105 offset:28672
    ds_read_b128 v[32:35], v15
    ds_read_b128 v[36:39], v15 offset:1280
    s_cmp_lg_u32 s60, 0
    s_waitcnt lgkmcnt(1)
    buffer_store_dwordx4 v[32:35], v11, s[12:15], s56 offen sc1
    s_cselect_b64 exec, 15, -1
    s_waitcnt lgkmcnt(0)
    buffer_store_dwordx4 v[36:39], v11, s[12:15], s56 offen offset:2048 sc1
    s_mov_b64 exec, -1
    s_cmp_lg_u32 s3, 7
    s_cbranch_scc1 K1_NOP8S
    v_lshlrev_b32 v108, 16, v102
    v_lshlrev_b32 v109, 16, v104
    v_lshlrev_b32 v110, 16, v103
    v_mov_b32 v111, 0
    ds_write_b128 v7, v[108:111] offset:3072
K1_NOP8S:
    s_setprio 0
    s_waitcnt lgkmcnt(0)
    s_barrier
    s_cmp_lg_u32 s3, 7
    s_cbranch_scc1 K1_NOP8T
    v_lshlrev_b32 v105, 2, v6
    ds_read_b32 v105, v105 offset:28672
    s_waitcnt lgkmcnt(0)
    v_add_u32 v105, 0xffff, v105
    v_and_b32 v105, 0xffff0000, v105
    v_or_b32 v103, v103, v105
    v_lshl_or_b32 v102, v104, 16, v102
    v_lshlrev_b32 v100, 3, v100
    s_mov_b32 s58, 4587648
    v_cmp_gt_u32 vcc, 49, v6
    s_and_b64 exec, exec, vcc
    buffer_store_dwordx2 v[102:103], v100, s[12:15], s58 offen sc1
    s_mov_b64 exec, -1
K1_NOP8T:
    buffer_load_ushort v126, v107, s[84:87], s93 offen
    buffer_load_ushort v127, v107, s[84:87], s93 offen offset:128
    buffer_load_ushort v128, v107, s[84:87], s93 offen offset:64
    buffer_load_ushort v129, v107, s[84:87], s93 offen offset:192
    buffer_load_ushort v180, v107, s[88:91], 0 offen
    buffer_load_ushort v182, v107, s[88:91], 0 offen offset:64
    s_add_u32 m0, s57, 4096
    s_mov_b32 s48, s59
    buffer_load_dwordx4 v11, s[8:11], s48 offen offset:0 lds
    s_add_u32 s48, s48, 1024
    buffer_load_dwordx4 v11, s[8:11], s48 offen offset:1024 lds
    s_add_u32 s48, s48, 1024
    buffer_load_dwordx4 v11, s[8:11], s48 offen offset:2048 lds
    s_add_u32 s48, s48, 1024
    buffer_load_dwordx4 v11, s[8:11], s48 offen offset:3072 lds
    s_lshl_b32 s48, s3, 12
    s_add_u32 m0, s48, 97152
    s_sub_u32 s48, s48, 16384
    buffer_load_dwordx4 v7, s[4:7], s48 offen offset:0 lds
    buffer_load_dwordx4 v7, s[4:7], s48 offen offset:1024 lds
    buffer_load_dwordx4 v7, s[4:7], s48 offen offset:2048 lds
    buffer_load_dwordx4 v7, s[4:7], s48 offen offset:3072 lds
    v_mov_b32 v80, v6
    v_lshrrev_b32 v81, 5, v80
    v_and_b32 v82, 31, v80
    v_bfe_u32 v83, v80, 2, 2
    v_and_b32 v84, 3, v80
    v_bfe_u32 v85, v80, 4, 1
    v_lshrrev_b32 v86, 3, v80
    v_lshlrev_b32 v229, 5, v86
    v_and_b32 v86, 7, v80
    v_lshlrev_b32 v87, 2, v85
    v_xor_b32 v86, v86, v87
    v_lshlrev_b32 v216, 4, v86
    v_lshl_add_u32 v86, v81, 3, v83
    v_lshlrev_b32 v86, 7, v86
    v_lshl_add_u32 v86, v85, 5, v86
    v_lshl_add_u32 v86, v84, 3, v86
    v_add_u32 v86, 129920, v86
    v_lshrrev_b32 v87, 1, v83
    v_lshl_add_u32 v220, v87, 6, v86
    v_xor_b32 v87, 1, v87
    v_lshl_add_u32 v221, v87, 6, v86
    v_lshlrev_b32 v228, 7, v82
    v_add_u32 v228, 97152, v228
    v_and_b32 v86, 1, v80
    v_lshl_or_b32 v86, v83, 1, v86
    v_lshl_add_u32 v228, v86, 4, v228
    v_bfe_u32 v86, v80, 1, 1
    v_xor_b32 v86, v86, v81
    v_lshl_add_u32 v228, v86, 3, v228
    v_lshl_add_u32 v84, v85, 2, v84
    v_and_b32 v86, 1, v83
    v_lshl_or_b32 v86, v81, 1, v86
    v_xor_b32 v86, v86, v84
    v_lshrrev_b32 v87, 1, v83
    v_lshl_add_u32 v83, v81, 2, v83
    v_lshlrev_b32 v240, 7, v83
    v_lshl_add_u32 v224, v87, 3, v240
    v_add_u32 v224, 97152, v224
    v_xor_b32 v87, 4, v86
    v_lshl_add_u32 v225, v87, 4, v224
    v_add_u32 v225, 1024, v225
    v_lshl_add_u32 v224, v86, 4, v224
    v_xor_b32 v226, 8, v224
    v_xor_b32 v227, 8, v225
    v_mul_u32_u24 v240, 144, v83
    v_lshl_add_u32 v240, v84, 3, v240
    v_add_u32 v240, 37376, v240
    v_mul_u32_u24 v230, 528, v81
    v_lshl_add_u32 v230, v82, 3, v230
    v_add_u32 v230, 71168, v230
    v_bfe_u32 v86, v80, 3, 2
    v_lshl_add_u32 v86, v86, 1, v81
    v_lshlrev_b32 v231, 5, v86
    v_and_b32 v86, 4, v80
    v_lshl_add_u32 v231, v86, 1, v231
    v_and_b32 v86, 1, v80
    v_lshl_add_u32 v231, v86, 4, v231
    v_lshlrev_b32 v241, 3, v80
    v_lshlrev_b32 v86, 4, v86
    v_mov_b32 v243, 0x3f80
    v_lshlrev_b32 v243, v86, v243
    v_lshrrev_b32 v86, 1, v80
    v_lshlrev_b32 v86, 2, v86
    v_lshl_add_u32 v242, v80, 4, v86
    v_and_b32 v86, 3, v80
    v_bfe_u32 v87, v80, 2, 3
    v_lshl_add_u32 v86, v86, 3, v87
    v_and_b32 v87, 3, v86
    v_xor_b32 v236, 1, v87
    v_lshl_or_b32 v236, v236, 2, v87
    v_mul_u32_u24 v236, 0x1111, v236
    v_lshrrev_b32 v86, 2, v86
    v_lshlrev_b32 v87, 2, v81
    v_sub_u32 v86, v86, v87
    v_mov_b32 v87, 0x3f80
    v_cmp_eq_u32 s[76:77], 0, v86
    v_cmp_eq_u32 s[78:79], 1, v86
    v_cmp_eq_u32 s[80:81], 2, v86
    v_cmp_eq_u32 s[82:83], 3, v86
    v_cndmask_b32 v232, 0, v87, s[76:77]
    v_cndmask_b32 v233, 0, v87, s[78:79]
    v_cndmask_b32 v234, 0, v87, s[80:81]
    v_cndmask_b32 v235, 0, v87, s[82:83]
    v_and_b32 v86, 15, v80
    v_lshrrev_b32 v87, 4, v80
    v_mul_u32_u24 v244, 528, v86
    v_lshl_add_u32 v244, v87, 6, v244
    v_add_u32 v244, 71168, v244
    v_lshlrev_b32 v247, 7, v86
    v_bfe_u32 v86, v80, 1, 3
    v_xor_b32 v86, v86, v87
    v_lshl_add_u32 v245, v86, 4, v247
    v_add_u32 v245, 46592, v245
    v_xor_b32 v246, 64, v245
    v_lshl_add_u32 v247, v87, 4, v247
    s_lshl_b32 s44, s3, 12
    s_and_b32 s45, s3, 3
    s_mul_i32 s46, s45, 8448
    s_lshl_b32 s45, s45, 11
    v_add_u32 v220, s44, v220
    v_add_u32 v221, s44, v221
    v_add_u32 v224, s44, v224
    v_add_u32 v225, s44, v225
    v_add_u32 v226, s44, v226
    v_add_u32 v227, s44, v227
    v_add_u32 v228, s44, v228
    v_add_u32 v244, s46, v244
    v_add_u32 v245, s45, v245
    v_add_u32 v246, s45, v246
    s_cmp_lg_u32 s3, 4
    s_cbranch_scc1 K1_NOLOW
    ds_write_b128 v7, v[176:179]
    ds_write_b128 v7, v[176:179] offset:1024
    ds_write_b128 v7, v[176:179] offset:2048
    s_mov_b64 exec, 0xff
    ds_write_b32 v242, v243 offset:528
    s_mov_b64 exec, -1
K1_NOLOW:
    v_lshlrev_b32 v4, 4, v0
    v_cmp_gt_u32 vcc, 468, v0
    s_mul_i32 s49, s43, 15744
    s_add_u32 s48, s49, 8192
    s_waitcnt lgkmcnt(0)
    s_barrier
    ds_read_b128 v[108:111], v4 offset:6144
    ds_read_b128 v[190:193], v4 offset:14336
    s_waitcnt lgkmcnt(1)
    buffer_store_dwordx4 v[108:111], v4, s[12:15], s49 offen sc1
    s_and_b64 exec, exec, vcc
    s_cbranch_execz K1_COT
    s_waitcnt lgkmcnt(0)
    buffer_store_dwordx4 v[190:193], v4, s[12:15], s48 offen sc1
K1_COT:
    s_mov_b64 exec, -1
    s_waitcnt vmcnt(2)
    ds_read_b64_tr_b16 v[132:133], v12 offset:4096
    ds_read_b64_tr_b16 v[134:135], v12 offset:4352
    ds_read_b64_tr_b16 v[136:137], v12 offset:5120
    ds_read_b64_tr_b16 v[138:139], v12 offset:5376
    ds_read_b64_tr_b16 v[140:141], v12 offset:6144
    ds_read_b64_tr_b16 v[142:143], v12 offset:6400
    ds_read_b64_tr_b16 v[144:145], v12 offset:7168
    ds_read_b64_tr_b16 v[146:147], v12 offset:7424
    v_lshrrev_b32 v14, 4, v6
    v_bfe_u32 v15, v6, 2, 2
    v_lshl_add_u32 v14, v14, 3, v15
    v_and_b32 v15, 3, v6
    v_lshlrev_b32 v15, 4, v15
    v_lshl_add_u32 v14, v14, 7, v15
    s_lshl_b32 s44, s3, 12
    s_add_u32 s44, s44, 97152
    v_add_u32 v14, s44, v14
    s_lshl_b32 s48, s3, 10
    s_add_u32 s48, s48, 50688
    v_add_u32 v15, s48, v7
    ds_read_b64_tr_b16 v[208:209], v14 offset:0
    ds_read_b64_tr_b16 v[210:211], v14 offset:512
    ds_read_b64_tr_b16 v[212:213], v14 offset:8
    ds_read_b64_tr_b16 v[214:215], v14 offset:520
    s_waitcnt lgkmcnt(10)
    v_mfma_f32_32x32x16_bf16 v[152:167], v[132:135], v[16:19], 0
    s_waitcnt lgkmcnt(8)
    v_mfma_f32_32x32x16_bf16 v[152:167], v[136:139], v[20:23], v[152:167]
    s_waitcnt lgkmcnt(6)
    v_mfma_f32_32x32x16_bf16 v[152:167], v[140:143], v[24:27], v[152:167]
    s_waitcnt lgkmcnt(4)
    v_mfma_f32_32x32x16_bf16 v[152:167], v[144:147], v[28:31], v[152:167]
    s_lshl_b32 s48, s60, 5
    v_add_u32 v9, s48, v9
    v_mul_u32_u24 v13, 144, v9
    v_lshl_add_u32 v13, v8, 3, v13
    s_lshl_b32 s48, s61, 6
    v_add_u32 v13, s48, v13
    s_mov_b32 s55, 0xbfb8aa3b
    s_waitcnt lgkmcnt(0)
    ds_write_b128 v15, v[208:211]
    ds_write_b128 v15, v[212:215] offset:4096
    ds_read_b64_tr_b16 v[208:209], v14 offset:64
    ds_read_b64_tr_b16 v[210:211], v14 offset:576
    ds_read_b64_tr_b16 v[212:213], v14 offset:72
    ds_read_b64_tr_b16 v[214:215], v14 offset:584
    v_add_u32 v14, s44, v7
    v_mul_f32 v152, s55, v152
    v_mul_f32 v153, s55, v153
    v_mul_f32 v154, s55, v154
    v_mul_f32 v155, s55, v155
    v_and_b32 v10, 0x7fffffff, v152
    v_and_b32 v11, 0x7fffffff, v153
    v_max_u32 v10, v10, v11
    v_and_b32 v11, 0x7fffffff, v154
    v_max_u32 v10, v10, v11
    v_and_b32 v11, 0x7fffffff, v155
    v_max_u32 v10, v10, v11
    v_cvt_pk_bf16_f32 v152, v152, v153
    v_cvt_pk_bf16_f32 v153, v154, v155
    ds_write_b64 v13, v[152:153] offset:37376
    v_mul_f32 v156, s55, v156
    v_mul_f32 v157, s55, v157
    v_mul_f32 v158, s55, v158
    v_mul_f32 v159, s55, v159
    v_and_b32 v11, 0x7fffffff, v156
    v_max_u32 v10, v10, v11
    v_and_b32 v11, 0x7fffffff, v157
    v_max_u32 v10, v10, v11
    v_and_b32 v11, 0x7fffffff, v158
    v_max_u32 v10, v10, v11
    v_and_b32 v11, 0x7fffffff, v159
    v_max_u32 v10, v10, v11
    v_cvt_pk_bf16_f32 v156, v156, v157
    v_cvt_pk_bf16_f32 v157, v158, v159
    ds_write_b64 v13, v[156:157] offset:37392
    v_mul_f32 v160, s55, v160
    v_mul_f32 v161, s55, v161
    v_mul_f32 v162, s55, v162
    v_mul_f32 v163, s55, v163
    v_and_b32 v11, 0x7fffffff, v160
    v_max_u32 v10, v10, v11
    v_and_b32 v11, 0x7fffffff, v161
    v_max_u32 v10, v10, v11
    v_and_b32 v11, 0x7fffffff, v162
    v_max_u32 v10, v10, v11
    v_and_b32 v11, 0x7fffffff, v163
    v_max_u32 v10, v10, v11
    v_cvt_pk_bf16_f32 v160, v160, v161
    v_cvt_pk_bf16_f32 v161, v162, v163
    ds_write_b64 v13, v[160:161] offset:37408
    v_mul_f32 v164, s55, v164
    v_mul_f32 v165, s55, v165
    v_mul_f32 v166, s55, v166
    v_mul_f32 v167, s55, v167
    v_and_b32 v11, 0x7fffffff, v164
    v_max_u32 v10, v10, v11
    v_and_b32 v11, 0x7fffffff, v165
    v_max_u32 v10, v10, v11
    v_and_b32 v11, 0x7fffffff, v166
    v_max_u32 v10, v10, v11
    v_and_b32 v11, 0x7fffffff, v167
    v_max_u32 v10, v10, v11
    v_cvt_pk_bf16_f32 v164, v164, v165
    v_cvt_pk_bf16_f32 v165, v166, v167
    ds_write_b64 v13, v[164:165] offset:37424
    v_lshlrev_b32 v9, 4, v9
    ds_max_u32 v9, v10 offset:3084
    s_waitcnt lgkmcnt(5)
    ds_write_b128 v15, v[208:211] offset:8192
    ds_write_b128 v15, v[212:215] offset:12288
    ds_write_b128 v14, v[176:179] offset:0
    ds_write_b128 v14, v[176:179] offset:1024
    ds_write_b128 v14, v[176:179] offset:2048
    ds_write_b128 v14, v[176:179] offset:3072
    s_setprio 0
K1_JOIN:
    s_mul_i32 s28, s2, 49
    s_lshl_b32 s42, s3, 10
    s_sub_u32 s29, 12500, s28
    s_min_u32 s29, s29, 49
    s_mov_b32 s22, 1675000
    s_mov_b32 s23, 0x00020000
    s_movk_i32 s30, 128
    s_mov_b32 s31, 0x0000bf80
    s_mov_b32 s32, 0xbf800000
    s_mov_b32 s33, 4587648
    s_mov_b32 s34, 4688000
    s_mov_b32 s49, 32
    s_mov_b32 s50, 1
    s_mov_b32 s72, 0x13131313
    s_mov_b32 s73, 0x13131313
    s_mov_b32 s74, 0x02020202
    s_mov_b32 s75, 0x02020202
    s_add_u32 s69, s70, 1
    s_addc_u32 s70, s71, 0
    s_and_b32 s56, s70, 15
    s_bfe_u32 s57, s70, 0x40004
    s_lshl_b32 s56, s56, 12
    s_lshl_b32 s57, s57, 28
    s_or_b32 s68, s56, s57
    v_and_b32 v149, 3, v0
    v_lshlrev_b32 v149, 2, v149
    v_lshrrev_b32 v2, 2, v0
    v_mul_u32_u24 v1, 15744, v2
    v_lshlrev_b32 v2, 5, v2
    s_lshr_b32 s62, s2, 2
    s_mul_i32 s62, s62, 8320
    s_and_b32 s63, s2, 3
    s_lshl3_add_u32 s62, s63, s62
    s_add_u32 s62, s62, 4030464
    s_add_u32 s63, s62, 4096
    s_cmp_lg_u32 s3, 0
    s_cbranch_scc1 K1_NOOFF
    v_lshl_or_b32 v16, v103, 16, v102
    v_lshl_or_b32 v18, v104, 16, v103
    v_lshl_or_b32 v20, v105, 16, v104
    v_lshl_or_b32 v22, v100, 16, v105
    v_or_b32 v16, s68, v16
    v_or_b32 v18, s68, v18
    v_or_b32 v20, s68, v20
    v_or_b32 v22, s68, v22
    v_mov_b32 v17, s69
    v_mov_b32 v19, s69
    v_mov_b32 v21, s69
    v_mov_b32 v23, s69
    s_mul_i32 s48, s43, 32
    s_add_u32 s48, s48, 4030464
    v_mul_u32_u24 v4, 8320, v6
    s_add_u32 s59, s48, 16
    s_waitcnt vmcnt(0) lgkmcnt(0)
    s_barrier
    buffer_store_dwordx4 v[16:19], v4, s[12:15], s48 offen sc1
    buffer_store_dwordx4 v[20:23], v4, s[12:15], s59 offen sc1
    s_branch K1_PUB
K1_NOOFF:
    s_waitcnt vmcnt(0) lgkmcnt(0)
    s_barrier
K1_PUB:
    s_mov_b32 s56, 0xf000f000
    s_mov_b32 s57, 1048576
    s_cmp_lg_u32 s3, 7
    s_cbranch_scc1 K1_GATED
    s_mov_b64 exec, 0xffffffff
K1_GATE:
    buffer_load_dwordx2 v[164:165], v2, s[12:15], s63 offen offset:0 sc1
    s_sub_u32 s57, s57, 1
    s_cbranch_scc1 K1_GATED
    s_waitcnt vmcnt(0)
    v_cmp_ne_u32 vcc, s69, v165
    s_cbranch_vccz K1_GATED
    s_sleep 4
    s_branch K1_GATE
K1_GATED:
    s_mov_b64 exec, -1
    s_barrier
K1_POLL:
    buffer_load_dwordx2 v[162:163], v2, s[12:15], s62 offen sc1
    buffer_load_dwordx2 v[164:165], v2, s[12:15], s63 offen sc1
    s_sub_u32 s57, s57, 1
    s_cbranch_scc1 K1_GOT
    s_waitcnt vmcnt(0)
    v_and_b32 v166, s56, v162
    v_mov_b32 v167, v163
    v_and_b32 v168, s56, v164
    v_mov_b32 v169, v165
    v_cmp_ne_u64 vcc, s[68:69], v[166:167]
    v_cmp_ne_u64 s[58:59], s[68:69], v[168:169]
    s_or_b64 exec, vcc, s[58:59]
    s_cbranch_execz K1_GOT
    s_sleep 4
    s_branch K1_POLL
K1_GOT:
    s_mov_b64 exec, -1
    s_not_b32 s56, s56
    s_waitcnt vmcnt(0)
    v_and_b32 v188, s56, v162
    v_and_b32 v189, s56, v164
    v_add_u32_sdwa v186, v149, v188 dst_sel:DWORD dst_unused:UNUSED_PAD src0_sel:DWORD src1_sel:WORD_0
    v_add_u32_sdwa v187, v149, v189 dst_sel:DWORD dst_unused:UNUSED_PAD src0_sel:DWORD src1_sel:WORD_0
K2_ROUND:
    s_mov_b32 s7, 2015232
    s_movk_i32 s57, 12544
    s_mov_b32 s58, 2027776
    v_add_u32 v107, v186, v1
    v_and_b32 v107, -4, v107
    buffer_load_dwordx2 v[50:51], v107, s[12:15], s57 offen
    v_add_u32 v191, v187, v1
    v_and_b32 v191, -4, v191
    buffer_load_dwordx2 v[54:55], v191, s[12:15], s58 offen
    v_sub_u32 v195, s49, v149
    v_sub_u32_sdwa v193, v188, v186 dst_sel:DWORD dst_unused:UNUSED_PAD src0_sel:WORD_1 src1_sel:DWORD
    v_lshl_add_u32 v106, v186, 2, v1
    v_cmp_gt_i32 s[76:77], v193, v195
    v_min_i32 v193, v193, v195
    v_cmp_lt_i32 vcc, 16, v193
    s_or_b64 exec, vcc, 1
    buffer_load_dwordx2 v[52:53], v107, s[12:15], s57 offen offset:16
    s_mov_b64 exec, -1
    v_sub_u32_sdwa v194, v189, v187 dst_sel:DWORD dst_unused:UNUSED_PAD src0_sel:WORD_1 src1_sel:DWORD
    v_lshl_add_u32 v190, v187, 2, v1
    v_cmp_gt_i32 s[78:79], v194, v195
    v_min_i32 v194, v194, v195
    v_cmp_lt_i32 vcc, 16, v194
    s_or_b64 exec, vcc, 1
    buffer_load_dwordx2 v[56:57], v191, s[12:15], s58 offen offset:16
    s_mov_b64 exec, -1
    v_mov_b32 v108, 1
    v_lshrrev_b32 v113, 1, v241
    s_cmp_eq_u32 s50, 0
    s_cbranch_scc1 K2_NOTFIRST
    v_cmp_gt_u32 vcc, 32, v6
    s_mov_b32 s48, 0xbf317218
    s_mov_b32 s55, 0xbfb8aa3b
    v_lshlrev_b32 v126, 16, v126
    v_lshlrev_b32 v127, 16, v127
    v_mul_f32 v126, s55, v126
    v_mul_f32 v127, s55, v127
    v_cvt_pk_bf16_f32 v24, v126, v126
    v_lshlrev_b32 v24, 16, v24
    v_sub_f32 v25, v126, v24
    v_cvt_pk_bf16_f32 v26, v24, v25
    v_cvt_pk_bf16_f32 v27, 0, v127
    v_cndmask_b32 v114, v26, 0, vcc
    v_cndmask_b32 v115, v27, 0, vcc
    v_cndmask_b32 v118, 0, v26, vcc
    v_cndmask_b32 v119, 0, v27, vcc
    v_lshlrev_b32 v180, 16, v180
    v_mul_f32 v180, s48, v180
    v_lshlrev_b32 v128, 16, v128
    v_lshlrev_b32 v129, 16, v129
    v_mul_f32 v128, s55, v128
    v_mul_f32 v129, s55, v129
    v_cvt_pk_bf16_f32 v24, v128, v128
    v_lshlrev_b32 v24, 16, v24
    v_sub_f32 v25, v128, v24
    v_cvt_pk_bf16_f32 v26, v24, v25
    v_cvt_pk_bf16_f32 v27, 0, v129
    v_cndmask_b32 v120, v26, 0, vcc
    v_cndmask_b32 v121, v27, 0, vcc
    v_cndmask_b32 v124, 0, v26, vcc
    v_cndmask_b32 v125, 0, v27, vcc
    v_lshlrev_b32 v182, 16, v182
    v_mul_f32 v182, s48, v182
    s_mov_b32 s92, 0x7fffffff
    v_and_b32 v24, s92, v126
    v_and_b32 v25, s92, v128
    v_and_b32 v26, s92, v127
    v_and_b32 v27, s92, v129
    v_max_u32 v24, v24, v25
    v_max_u32 v26, v26, v27
    s_nop 0
    v_max_u32_dpp v24, v24, v24 row_shr:1 row_mask:0xf bank_mask:0xf bound_ctrl:0
    v_max_u32_dpp v26, v26, v26 row_shr:1 row_mask:0xf bank_mask:0xf bound_ctrl:0
    s_nop 0
    v_max_u32_dpp v24, v24, v24 row_shr:2 row_mask:0xf bank_mask:0xf bound_ctrl:0
    v_max_u32_dpp v26, v26, v26 row_shr:2 row_mask:0xf bank_mask:0xf bound_ctrl:0
    s_nop 0
    v_max_u32_dpp v24, v24, v24 row_shr:4 row_mask:0xf bank_mask:0xf bound_ctrl:0
    v_max_u32_dpp v26, v26, v26 row_shr:4 row_mask:0xf bank_mask:0xf bound_ctrl:0
    s_nop 0
    v_max_u32_dpp v24, v24, v24 row_shr:8 row_mask:0xf bank_mask:0xf bound_ctrl:0
    v_max_u32_dpp v26, v26, v26 row_shr:8 row_mask:0xf bank_mask:0xf bound_ctrl:0
    s_nop 0
    v_max_u32_dpp v24, v24, v24 row_bcast:15 row_mask:0xa bank_mask:0xf
    v_max_u32_dpp v26, v26, v26 row_bcast:15 row_mask:0xa bank_mask:0xf
    s_mov_b32 s91, 0x3f800000
    s_mov_b32 s4, 4686976
    s_mov_b32 s5, 4685952
    s_mov_b32 s6, 4684928
    s_mov_b32 s92, 0x7fff0000
    v_readlane_b32 s89, v24, 31
    v_readlane_b32 s90, v26, 31
    s_mov_b64 s[86:87], 1
    s_mov_b32 s88, 0
    s_waitcnt vmcnt(0)
    s_branch K2_COUNT
K2_NOTFIRST:
    s_waitcnt lgkmcnt(0)
    s_barrier
    s_waitcnt vmcnt(0)
K2_COUNT:
    s_or_b64 vcc, s[76:77], s[78:79]
    s_cbranch_scc0 K2_NOFLAG
    v_mov_b32 v109, 512
    ds_write_b32 v109, v108
K2_NOFLAG:
    v_cmpx_lt_i32 vcc, 0, v193
    v_alignbyte_b32 v50, v51, v50, v186
    v_lshlrev_b32_sdwa v58, 2, v50 dst_sel:DWORD dst_unused:UNUSED_PAD src0_sel:DWORD src1_sel:BYTE_0
    ds_add_rtn_u32 v74, v58, v108 offset:0
    v_cmpx_lt_i32 vcc, 1, v193
    v_lshlrev_b32_sdwa v59, 2, v50 dst_sel:DWORD dst_unused:UNUSED_PAD src0_sel:DWORD src1_sel:BYTE_1
    ds_add_rtn_u32 v75, v59, v108 offset:0
    v_cmpx_lt_i32 vcc, 2, v193
    v_lshlrev_b32_sdwa v60, 2, v50 dst_sel:DWORD dst_unused:UNUSED_PAD src0_sel:DWORD src1_sel:BYTE_2
    ds_add_rtn_u32 v76, v60, v108 offset:0
    v_cmpx_lt_i32 vcc, 3, v193
    v_lshlrev_b32_sdwa v61, 2, v50 dst_sel:DWORD dst_unused:UNUSED_PAD src0_sel:DWORD src1_sel:BYTE_3
    ds_add_rtn_u32 v77, v61, v108 offset:0
    v_cmpx_lt_i32 vcc, 16, v193
    s_cbranch_execz K2_CNT_0
    v_alignbyte_b32 v52, v53, v52, v186
    v_lshlrev_b32_sdwa v62, 2, v52 dst_sel:DWORD dst_unused:UNUSED_PAD src0_sel:DWORD src1_sel:BYTE_0
    ds_add_rtn_u32 v78, v62, v108 offset:0
    v_cmpx_lt_i32 vcc, 17, v193
    s_cbranch_execz K2_CNT_0
    v_lshlrev_b32_sdwa v63, 2, v52 dst_sel:DWORD dst_unused:UNUSED_PAD src0_sel:DWORD src1_sel:BYTE_1
    ds_add_rtn_u32 v79, v63, v108 offset:0
    v_cmpx_lt_i32 vcc, 18, v193
    s_cbranch_execz K2_CNT_0
    v_lshlrev_b32_sdwa v64, 2, v52 dst_sel:DWORD dst_unused:UNUSED_PAD src0_sel:DWORD src1_sel:BYTE_2
    ds_add_rtn_u32 v80, v64, v108 offset:0
    v_cmpx_lt_i32 vcc, 19, v193
    s_cbranch_execz K2_CNT_0
    v_lshlrev_b32_sdwa v65, 2, v52 dst_sel:DWORD dst_unused:UNUSED_PAD src0_sel:DWORD src1_sel:BYTE_3
    ds_add_rtn_u32 v81, v65, v108 offset:0
K2_CNT_0:
    s_mov_b64 exec, -1
    v_cmpx_lt_i32 vcc, 0, v194
    v_alignbyte_b32 v54, v55, v54, v187
    v_lshlrev_b32_sdwa v66, 2, v54 dst_sel:DWORD dst_unused:UNUSED_PAD src0_sel:DWORD src1_sel:BYTE_0
    ds_add_rtn_u32 v82, v66, v108 offset:0
    v_cmpx_lt_i32 vcc, 1, v194
    v_lshlrev_b32_sdwa v67, 2, v54 dst_sel:DWORD dst_unused:UNUSED_PAD src0_sel:DWORD src1_sel:BYTE_1
    ds_add_rtn_u32 v83, v67, v108 offset:0
    v_cmpx_lt_i32 vcc, 2, v194
    v_lshlrev_b32_sdwa v68, 2, v54 dst_sel:DWORD dst_unused:UNUSED_PAD src0_sel:DWORD src1_sel:BYTE_2
    ds_add_rtn_u32 v84, v68, v108 offset:0
    v_cmpx_lt_i32 vcc, 3, v194
    v_lshlrev_b32_sdwa v69, 2, v54 dst_sel:DWORD dst_unused:UNUSED_PAD src0_sel:DWORD src1_sel:BYTE_3
    ds_add_rtn_u32 v85, v69, v108 offset:0
    v_cmpx_lt_i32 vcc, 16, v194
    s_cbranch_execz K2_CNT_1
    v_alignbyte_b32 v56, v57, v56, v187
    v_lshlrev_b32_sdwa v70, 2, v56 dst_sel:DWORD dst_unused:UNUSED_PAD src0_sel:DWORD src1_sel:BYTE_0
    ds_add_rtn_u32 v86, v70, v108 offset:0
    v_cmpx_lt_i32 vcc, 17, v194
    s_cbranch_execz K2_CNT_1
    v_lshlrev_b32_sdwa v71, 2, v56 dst_sel:DWORD dst_unused:UNUSED_PAD src0_sel:DWORD src1_sel:BYTE_1
    ds_add_rtn_u32 v87, v71, v108 offset:0
    v_cmpx_lt_i32 vcc, 18, v194
    s_cbranch_execz K2_CNT_1
    v_lshlrev_b32_sdwa v72, 2, v56 dst_sel:DWORD dst_unused:UNUSED_PAD src0_sel:DWORD src1_sel:BYTE_2
    ds_add_rtn_u32 v88, v72, v108 offset:0
    v_cmpx_lt_i32 vcc, 19, v194
    s_cbranch_execz K2_CNT_1
    v_lshlrev_b32_sdwa v73, 2, v56 dst_sel:DWORD dst_unused:UNUSED_PAD src0_sel:DWORD src1_sel:BYTE_3
    ds_add_rtn_u32 v89, v73, v108 offset:0
K2_CNT_1:
    s_mov_b64 exec, -1
    buffer_load_dwordx4 v[34:37], v106, s[12:15], 0 offen offset:0
    buffer_load_dwordx4 v[42:45], v190, s[12:15], s7 offen offset:0
    v_cmpx_lt_i32 vcc, 16, v193
    s_cbranch_execz K2_RL_0
    buffer_load_dwordx4 v[38:41], v106, s[12:15], 0 offen offset:64
K2_RL_0:
    s_mov_b64 exec, -1
    v_cmpx_lt_i32 vcc, 16, v194
    s_cbranch_execz K2_RL_1
    buffer_load_dwordx4 v[46:49], v190, s[12:15], s7 offen offset:64
K2_RL_1:
    s_mov_b64 exec, -1
    v_mov_b32 v106, 512
    s_movk_i32 s56, 4096
    s_waitcnt lgkmcnt(0)
    s_barrier
    s_cmp_eq_u32 s50, 0
    s_cbranch_scc1 K2_NOTOUCH
    s_lshl3_add_u32 s44, s54, s3
    s_mul_i32 s44, s44, 512
    s_add_u32 s44, s44, 4587648
    v_lshlrev_b32 v148, 4, v241
    s_mov_b64 exec, 15
    buffer_load_dword v148, v148, s[12:15], s44 offen
    s_mov_b64 exec, -1
K2_NOTOUCH:
    s_or_b32 s57, s2, s3
    s_cbranch_scc0 K2_EPOCH
K2_EPOCH_RET:
    ds_read_b32 v109, v113 offset:0
    ds_read_b32 v107, v106
    s_waitcnt lgkmcnt(1)
    v_mov_b32 v106, v109
    s_nop 1
    v_add_u32_dpp v106, v106, v106 row_shr:1 row_mask:0xf bank_mask:0xf bound_ctrl:0
    s_nop 1
    v_add_u32_dpp v106, v106, v106 row_shr:2 row_mask:0xf bank_mask:0xf bound_ctrl:0
    s_nop 1
    v_add_u32_dpp v106, v106, v106 row_shr:4 row_mask:0xf bank_mask:0xf bound_ctrl:0
    s_nop 1
    v_add_u32_dpp v106, v106, v106 row_shr:8 row_mask:0xf bank_mask:0xf bound_ctrl:0
    s_nop 1
    v_add_u32_dpp v106, v106, v106 row_bcast:15 row_mask:0xa bank_mask:0xf
    s_nop 1
    v_add_u32_dpp v106, v106, v106 row_bcast:31 row_mask:0xc bank_mask:0xf
    v_sub_u32 v109, v106, v109
    v_readlane_b32 s51, v106, 63
    v_lshl_add_u32 v109, v109, 3, s56
    ds_write_b32 v113, v109 offset:256
    ds_read_b32 v90, v58 offset:256
    ds_read_b32 v91, v59 offset:256
    ds_read_b32 v92, v60 offset:256
    ds_read_b32 v93, v61 offset:256
    ds_read_b32 v98, v66 offset:256
    ds_read_b32 v99, v67 offset:256
    ds_read_b32 v100, v68 offset:256
    ds_read_b32 v101, v69 offset:256
    v_cmpx_lt_i32 vcc, 16, v193
    s_cbranch_execz K2_SR_0
    ds_read_b32 v94, v62 offset:256
    ds_read_b32 v95, v63 offset:256
    ds_read_b32 v96, v64 offset:256
    ds_read_b32 v97, v65 offset:256
K2_SR_0:
    s_mov_b64 exec, -1
    v_cmpx_lt_i32 vcc, 16, v194
    s_cbranch_execz K2_SR_1
    ds_read_b32 v102, v70 offset:256
    ds_read_b32 v103, v71 offset:256
    ds_read_b32 v104, v72 offset:256
    ds_read_b32 v105, v73 offset:256
K2_SR_1:
    s_mov_b64 exec, -1
    s_cmp_gt_u32 s51, 4096
    s_cbranch_scc1 K2_OVER
    s_add_u32 s60, s51, 31
    s_lshr_b32 s60, s60, 5
    s_lshr_b32 s57, s60, 3
    s_and_b32 s58, s60, 7
    s_mul_i32 s52, s3, s57
    s_min_u32 s59, s3, s58
    s_add_u32 s52, s52, s59
    s_cmp_lt_u32 s3, s58
    s_addc_u32 s57, s57, s52
    s_lshl_b32 s52, s52, 8
    s_lshl_b32 s35, s57, 8
    s_lshl_b32 s51, s51, 3
    s_min_u32 s35, s35, s51
    s_lshl2_add_u32 m0, s42, 129920
    s_mov_b64 s[38:39], 0
    s_movk_i32 s41, 512
    s_cmp_lg_u32 s3, 0
    s_cbranch_scc1 K2_NOPAD
    v_add_u32 v106, s51, v241
    v_mov_b32 v196, 0
    v_mov_b32 v197, 784
    ds_write_b64 v106, v[196:197] offset:4096
K2_NOPAD:
    s_waitcnt vmcnt(0) lgkmcnt(0)
    v_readfirstlane_b32 s53, v107
    v_cmpx_lt_i32 vcc, 0, v193
    v_lshl_add_u32 v90, v74, 3, v90
    v_mov_b32 v196, v34
    v_lshlrev_b32 v197, 2, v58
    ds_write_b64 v90, v[196:197]
    v_cmpx_lt_i32 vcc, 1, v193
    v_lshl_add_u32 v91, v75, 3, v91
    v_mov_b32 v198, v35
    v_lshlrev_b32 v199, 2, v59
    ds_write_b64 v91, v[198:199]
    v_cmpx_lt_i32 vcc, 2, v193
    v_lshl_add_u32 v92, v76, 3, v92
    v_mov_b32 v200, v36
    v_lshlrev_b32 v201, 2, v60
    ds_write_b64 v92, v[200:201]
    v_cmpx_lt_i32 vcc, 3, v193
    v_lshl_add_u32 v93, v77, 3, v93
    v_mov_b32 v202, v37
    v_lshlrev_b32 v203, 2, v61
    ds_write_b64 v93, v[202:203]
    v_cmpx_lt_i32 vcc, 16, v193
    s_cbranch_execz K2_SC_0
    v_lshl_add_u32 v94, v78, 3, v94
    v_mov_b32 v196, v38
    v_lshlrev_b32 v197, 2, v62
    ds_write_b64 v94, v[196:197]
    v_cmpx_lt_i32 vcc, 17, v193
    s_cbranch_execz K2_SC_0
    v_lshl_add_u32 v95, v79, 3, v95
    v_mov_b32 v198, v39
    v_lshlrev_b32 v199, 2, v63
    ds_write_b64 v95, v[198:199]
    v_cmpx_lt_i32 vcc, 18, v193
    s_cbranch_execz K2_SC_0
    v_lshl_add_u32 v96, v80, 3, v96
    v_mov_b32 v200, v40
    v_lshlrev_b32 v201, 2, v64
    ds_write_b64 v96, v[200:201]
    v_cmpx_lt_i32 vcc, 19, v193
    s_cbranch_execz K2_SC_0
    v_lshl_add_u32 v97, v81, 3, v97
    v_mov_b32 v202, v41
    v_lshlrev_b32 v203, 2, v65
    ds_write_b64 v97, v[202:203]
K2_SC_0:
    s_mov_b64 exec, -1
    v_cmpx_lt_i32 vcc, 0, v194
    v_lshl_add_u32 v98, v82, 3, v98
    v_mov_b32 v196, v42
    v_lshlrev_b32 v197, 2, v66
    ds_write_b64 v98, v[196:197]
    v_cmpx_lt_i32 vcc, 1, v194
    v_lshl_add_u32 v99, v83, 3, v99
    v_mov_b32 v198, v43
    v_lshlrev_b32 v199, 2, v67
    ds_write_b64 v99, v[198:199]
    v_cmpx_lt_i32 vcc, 2, v194
    v_lshl_add_u32 v100, v84, 3, v100
    v_mov_b32 v200, v44
    v_lshlrev_b32 v201, 2, v68
    ds_write_b64 v100, v[200:201]
    v_cmpx_lt_i32 vcc, 3, v194
    v_lshl_add_u32 v101, v85, 3, v101
    v_mov_b32 v202, v45
    v_lshlrev_b32 v203, 2, v69
    ds_write_b64 v101, v[202:203]
    v_cmpx_lt_i32 vcc, 16, v194
    s_cbranch_execz K2_SC_1
    v_lshl_add_u32 v102, v86, 3, v102
    v_mov_b32 v196, v46
    v_lshlrev_b32 v197, 2, v70
    ds_write_b64 v102, v[196:197]
    v_cmpx_lt_i32 vcc, 17, v194
    s_cbranch_execz K2_SC_1
    v_lshl_add_u32 v103, v87, 3, v103
    v_mov_b32 v198, v47
    v_lshlrev_b32 v199, 2, v71
    ds_write_b64 v103, v[198:199]
    v_cmpx_lt_i32 vcc, 18, v194
    s_cbranch_execz K2_SC_1
    v_lshl_add_u32 v104, v88, 3, v104
    v_mov_b32 v200, v48
    v_lshlrev_b32 v201, 2, v72
    ds_write_b64 v104, v[200:201]
    v_cmpx_lt_i32 vcc, 19, v194
    s_cbranch_execz K2_SC_1
    v_lshl_add_u32 v105, v89, 3, v105
    v_mov_b32 v202, v49
    v_lshlrev_b32 v203, 2, v73
    ds_write_b64 v105, v[202:203]
K2_SC_1:
    s_mov_b64 exec, -1
    v_add_u32 v161, s52, v241
    v_add_u32 v173, s52, v229
    v_mfma_f32_32x32x16_bf16 v[2:17], v[176:179], v[176:179], 0
    v_mfma_f32_32x32x16_bf16 v[18:33], v[176:179], v[176:179], 0
    s_sub_u32 s40, s35, s52
    v_cmp_gt_i32 s[46:47], s40, v241
    v_mfma_f32_32x32x16_bf16 v[132:147], v[176:179], v[176:179], 0
    s_waitcnt lgkmcnt(0)
    s_barrier
    s_cmp_ge_u32 s52, s35
    s_cbranch_scc1 K2_NOWORK
K2_FILL:
    ds_read_b64 v[150:151], v161 offset:4096
    ds_read_b128 v[152:155], v173 offset:4096
    ds_read_b128 v[156:159], v173 offset:4112
    ds_read_b128 v[50:53], v173 offset:4352
    ds_read_b128 v[54:57], v173 offset:4368
    v_mfma_f32_32x32x16_bf16 v[64:79], v[176:179], v[176:179], 0
    v_mfma_f32_32x32x16_bf16 v[192:207], v[176:179], v[176:179], 0
    s_waitcnt lgkmcnt(4)
    v_mad_u32_u16 v161, v150, 8, 0
    buffer_load_dwordx2 v[174:175], v161, s[12:15], s33 offen
    s_waitcnt lgkmcnt(2)
    v_mad_u32_u16 v152, v152, s30, v216
    v_mad_u32_u16 v154, v154, s30, v216
    v_mad_u32_u16 v156, v156, s30, v216
    v_mad_u32_u16 v158, v158, s30, v216
    buffer_load_dwordx4 v152, s[12:15], s34 offen offset:0 lds
    buffer_load_dwordx4 v154, s[12:15], s4 offen offset:1024 lds
    buffer_load_dwordx4 v156, s[12:15], s5 offen offset:2048 lds
    buffer_load_dwordx4 v158, s[12:15], s6 offen offset:3072 lds
    s_waitcnt lgkmcnt(0)
    v_readfirstlane_b32 s36, v151
    v_mov_b32 v144, 1.0
    v_mov_b32 v145, 1.0
    v_mov_b32 v146, 1.0
    v_mov_b32 v147, 1.0
    s_min_u32 s36, s36, 656
    v_subrev_u32 v160, s36, v151
    v_cmp_gt_u32 vcc, s30, v160
    s_and_b64 s[44:45], vcc, s[46:47]
    s_mul_i32 s56, s36, 9
    v_add_u32 v184, s56, v240
    ds_read_b64_tr_b16 v[116:117], v184
    ds_read_b64_tr_b16 v[122:123], v184 offset:64
    ds_read_b128 v[162:165], v151 offset:3072
    ds_read_b64 v[126:127], v160 offset:528
    ds_read_b64 v[130:131], v160 offset:536
    v_mov_b32 v129, v150
    s_mov_b32 s43, s48
    s_bcnt1_i32_b64 s48, s[44:45]
    s_lshl3_add_u32 s52, s48, s52
    v_mad_u32_u16 v152, v50, s30, v216
    v_mad_u32_u16 v154, v52, s30, v216
    v_mad_u32_u16 v156, v54, s30, v216
    v_mad_u32_u16 v158, v56, s30, v216
    s_cmp_eq_u32 s86, 0
    s_cbranch_scc1 K2_NOEP1
    s_lshr_b32 s56, s3, 2
    s_lshl_b32 s56, s56, 13
    s_add_u32 s56, s56, 54784
    v_lshl_add_u32 v185, v241, 1, s56
    ds_read_b128 v[208:211], v245
    ds_read_b128 v[212:215], v246
    ds_read_b128 v[98:101], v185 offset:0
    ds_read_b128 v[102:105], v185 offset:1024
    ds_read_b128 v[106:109], v185 offset:4096
    ds_read_b128 v[110:113], v185 offset:5120
    v_mov_b32 v245, v185
    s_mov_b32 s86, 0
    v_mul_u32_u24 v242, 21846, v0
    s_mul_i32 s80, s28, 6
    s_add_u32 s80, s80, 1600000
    v_add_u32_sdwa v242, v242, v0 dst_sel:DWORD dst_unused:UNUSED_PAD src0_sel:WORD_1 src1_sel:DWORD
    s_mul_i32 s57, s29, 3
    v_cmp_gt_u32 s[84:85], s57, v0
    v_lshlrev_b32 v243, 3, v242
    v_lshlrev_b32 v242, 2, v242
    s_and_b32 s56, s3, 3
    s_lshl_b32 s56, s56, 4
    s_sub_i32 s57, s29, s56
    s_lshl_b32 s57, s57, 7
    v_cmp_gt_i32 s[82:83], s57, v247
    s_add_u32 s56, s56, s28
    s_lshl_b32 s56, s56, 7
    s_lshr_b32 s57, s3, 2
    s_lshl_b32 s57, s57, 6
    s_add_u32 s81, s56, s57
    s_waitcnt lgkmcnt(0)
    v_mfma_f32_16x16x32_bf16 v[248:251], v[98:101], v[208:211], 0
    v_mfma_f32_16x16x32_bf16 v[252:255], v[106:109], v[208:211], 0
    v_mfma_f32_16x16x32_bf16 v[248:251], v[102:105], v[212:215], v[248:251]
    v_mfma_f32_16x16x32_bf16 v[252:255], v[110:113], v[212:215], v[252:255]
K2_NOEP1:
    s_waitcnt lgkmcnt(0)
    v_permlane32_swap_b32 v126, v130
    v_permlane32_swap_b32 v127, v131
    s_waitcnt vmcnt(4)
    v_dot2_f32_bf16 v166, v174, s31, v162
    v_dot2_f32_bf16 v167, v174, s32, v163
    v_dot2_f32_bf16 v168, v175, s31, v164
    s_nop 0
    v_xor_b32 v161, v160, v228
    v_cndmask_b32 v172, v241, v161, s[44:45]
    v_cvt_pk_bf16_f32 v170, v166, v167
    v_cvt_pk_bf16_f32 v171, v168, 1.0
    v_dot2_f32_bf16 v169, v171, v171, -1.0
    v_dot2_f32_bf16 v169, v170, v170, v169
    s_nop 2
    v_cvt_pk_bf16_f32 v128, v169, v169
    s_waitcnt vmcnt(0)
    ds_read_b64_tr_b16 v[82:83], v220 offset:0
    ds_read_b64_tr_b16 v[84:85], v220 offset:512
    ds_read_b64_tr_b16 v[86:87], v220 offset:2048
    ds_read_b64_tr_b16 v[88:89], v220 offset:2560
    v_mfma_f32_32x32x16_bf16 v[34:49], v[126:129], v[116:119], 0
    ds_read_b64_tr_b16 v[90:91], v221 offset:0
    ds_read_b64_tr_b16 v[92:93], v221 offset:512
    ds_read_b64_tr_b16 v[94:95], v221 offset:2048
    ds_read_b64_tr_b16 v[96:97], v221 offset:2560
    s_waitcnt lgkmcnt(4)
    v_smfmac_f32_32x32x32_bf16 v[34:49], v[232:235], v[82:89], v236
    s_waitcnt lgkmcnt(0)
    buffer_load_dwordx4 v152, s[12:15], s34 offen offset:0 lds
    buffer_load_dwordx4 v154, s[12:15], s4 offen offset:1024 lds
    buffer_load_dwordx4 v156, s[12:15], s5 offen offset:2048 lds
    buffer_load_dwordx4 v158, s[12:15], s6 offen offset:3072 lds
    ds_write_b64 v172, v[170:171]
    v_dot2_f32_bf16 v166, v175, s91, v165
    v_and_b32 v167, s92, v150
    v_mul_f32 v167, s90, v167
    v_fmac_f32 v167, s89, v169
    v_add_f32 v166, v166, v167
    v_cmp_nge_f32 vcc, 0x42700000, v166
    s_setprio 3
    s_cmp_lg_u32 s87, 0
    s_cbranch_scc1 K2S_LOOP
    s_nop 1
    s_cbranch_vccnz K2S_LOOP
    .p2align 6
K2F_LOOP:
    s_sub_u32 s40, s35, s52
    s_cmp_le_i32 s40, s41
    s_cbranch_scc1 K2F_PRIO
K2F_PRIO_RET:
    v_mfma_f32_32x32x16_bf16 v[18:33], v[132:135], v[74:77], v[18:33]
    v_cvt_pk_bf16_f32 v78, v200, v201
    v_cvt_pk_bf16_f32 v79, v202, v203
    v_exp_f32 v140, v34
    v_exp_f32 v141, v35
    v_add_u32 v161, s52, v241
    v_exp_f32 v142, v36
    v_exp_f32 v143, v37
    v_rcp_f32 v144, v144
    v_rcp_f32 v145, v145
    v_pk_add_f32 v[140:141], v[140:141], 1.0 op_sel_hi:[1,0]
    v_pk_mul_f32 v[204:205], v[204:205], v[144:145]
    v_pk_mul_f32 v[206:207], v[206:207], v[144:145]
    v_pk_fma_f32 v[144:145], v[140:141], v[142:143], v[140:141]
    v_pk_fma_f32 v[200:201], v[34:35], v[142:143], v[34:35]
    v_pk_mul_f32 v[202:203], v[36:37], v[140:141]
    ds_read_b64_tr_b16 v[132:133], v224 offset:0
    ds_read_b64_tr_b16 v[134:135], v225 offset:0
    v_mfma_f32_32x32x16_bf16 v[50:65], v[126:129], v[122:125], 0
    v_cvt_pk_bf16_f32 v80, v204, v205
    v_cvt_pk_bf16_f32 v81, v206, v207
    v_exp_f32 v140, v38
    v_exp_f32 v141, v39
    v_add_u32 v173, s52, v229
    v_exp_f32 v142, v40
    v_exp_f32 v143, v41
    v_rcp_f32 v144, v144
    v_rcp_f32 v145, v145
    v_pk_add_f32 v[140:141], v[140:141], 1.0 op_sel_hi:[1,0]
    v_pk_mul_f32 v[200:201], v[200:201], v[144:145]
    v_pk_mul_f32 v[202:203], v[202:203], v[144:145]
    v_pk_fma_f32 v[144:145], v[140:141], v[142:143], v[140:141]
    v_pk_fma_f32 v[204:205], v[38:39], v[142:143], v[38:39]
    v_pk_mul_f32 v[206:207], v[40:41], v[140:141]
    ds_read_b64 v[150:151], v161 offset:4096
    ds_read_b128 v[152:155], v173 offset:4096
    ds_read_b128 v[156:159], v173 offset:4112
    v_smfmac_f32_32x32x32_bf16 v[50:65], v[232:235], v[90:97], v236
    v_cvt_pk_bf16_f32 v66, v200, v201
    v_cvt_pk_bf16_f32 v67, v202, v203
    v_exp_f32 v140, v42
    v_exp_f32 v141, v43
    v_exp_f32 v142, v44
    v_exp_f32 v143, v45
    v_rcp_f32 v144, v144
    v_rcp_f32 v145, v145
    v_pk_add_f32 v[140:141], v[140:141], 1.0 op_sel_hi:[1,0]
    v_pk_mul_f32 v[204:205], v[204:205], v[144:145]
    v_pk_mul_f32 v[206:207], v[206:207], v[144:145]
    v_pk_fma_f32 v[144:145], v[140:141], v[142:143], v[140:141]
    v_pk_fma_f32 v[200:201], v[42:43], v[142:143], v[42:43]
    v_pk_mul_f32 v[202:203], v[44:45], v[140:141]
    s_waitcnt lgkmcnt(2) vmcnt(0)
    ds_read_b64_tr_b16 v[98:99], v220 offset:0
    ds_read_b64_tr_b16 v[100:101], v220 offset:512
    ds_read_b64_tr_b16 v[102:103], v220 offset:2048
    ds_read_b64_tr_b16 v[104:105], v220 offset:2560
    ds_read_b64_tr_b16 v[106:107], v221 offset:0
    ds_read_b64_tr_b16 v[108:109], v221 offset:512
    ds_read_b64_tr_b16 v[110:111], v221 offset:2048
    ds_read_b64_tr_b16 v[112:113], v221 offset:2560
    v_mad_u32_u16 v161, v150, 8, 0
    buffer_load_dwordx2 v[174:175], v161, s[12:15], s33 offen
    v_mfma_f32_32x32x16_bf16 v[18:33], v[136:139], v[78:81], v[18:33]
    v_cvt_pk_bf16_f32 v68, v204, v205
    v_cvt_pk_bf16_f32 v69, v206, v207
    v_exp_f32 v140, v46
    v_exp_f32 v141, v47
    v_exp_f32 v142, v48
    v_exp_f32 v143, v49
    v_rcp_f32 v144, v144
    v_rcp_f32 v145, v145
    v_pk_add_f32 v[140:141], v[140:141], 1.0 op_sel_hi:[1,0]
    v_pk_mul_f32 v[200:201], v[200:201], v[144:145]
    v_pk_mul_f32 v[202:203], v[202:203], v[144:145]
    v_pk_fma_f32 v[144:145], v[140:141], v[142:143], v[140:141]
    v_pk_fma_f32 v[204:205], v[46:47], v[142:143], v[46:47]
    v_pk_mul_f32 v[206:207], v[48:49], v[140:141]
    s_waitcnt lgkmcnt(8)
    v_mad_u32_u16 v152, v152, s30, v216
    v_mad_u32_u16 v154, v154, s30, v216
    v_mad_u32_u16 v156, v156, s30, v216
    v_mad_u32_u16 v158, v158, s30, v216
    s_cmp_lg_u32 s39, 0
    s_cbranch_scc1 K2F_FLUSH
K2F_FLUSH_RET:
    ds_read_b64_tr_b16 v[136:137], v224 offset:2048
    ds_read_b64_tr_b16 v[138:139], v225 offset:2048
    v_mfma_f32_32x32x16_bf16 v[2:17], v[132:135], v[66:69], v[2:17]
    v_cvt_pk_bf16_f32 v70, v200, v201
    v_cvt_pk_bf16_f32 v71, v202, v203
    v_exp_f32 v140, v50
    v_exp_f32 v141, v51
    v_subrev_u32 v160, s36, v151
    v_cmp_gt_i32 s[46:47], s40, v241
    v_cmp_gt_u32 vcc, s30, v160
    v_exp_f32 v142, v52
    v_exp_f32 v143, v53
    v_rcp_f32 v144, v144
    v_rcp_f32 v145, v145
    v_pk_add_f32 v[140:141], v[140:141], 1.0 op_sel_hi:[1,0]
    v_pk_mul_f32 v[204:205], v[204:205], v[144:145]
    v_pk_mul_f32 v[206:207], v[206:207], v[144:145]
    v_pk_fma_f32 v[144:145], v[140:141], v[142:143], v[140:141]
    v_pk_fma_f32 v[200:201], v[50:51], v[142:143], v[50:51]
    v_pk_mul_f32 v[202:203], v[52:53], v[140:141]
    s_and_b64 s[44:45], vcc, s[46:47]
    s_cmp_lg_u64 s[44:45], s[46:47]
    s_cbranch_scc1 K2F_REBASE
K2F_REBASE_RET:
    s_mov_b32 s43, s48
    s_bcnt1_i32_b64 s48, s[44:45]
    s_lshl3_add_u32 s52, s48, s52
    s_waitcnt lgkmcnt(2)
    buffer_load_dwordx4 v152, s[12:15], s34 offen offset:0 lds
    buffer_load_dwordx4 v154, s[12:15], s4 offen offset:1024 lds
    buffer_load_dwordx4 v156, s[12:15], s5 offen offset:2048 lds
    buffer_load_dwordx4 v158, s[12:15], s6 offen offset:3072 lds
    v_mfma_f32_32x32x16_bf16 v[34:49], v[128:131], v[114:117], 0
    v_cvt_pk_bf16_f32 v72, v204, v205
    v_cvt_pk_bf16_f32 v73, v206, v207
    v_exp_f32 v140, v54
    v_exp_f32 v141, v55
    v_exp_f32 v142, v56
    v_exp_f32 v143, v57
    v_rcp_f32 v144, v144
    v_rcp_f32 v145, v145
    v_pk_add_f32 v[140:141], v[140:141], 1.0 op_sel_hi:[1,0]
    v_pk_mul_f32 v[200:201], v[200:201], v[144:145]
    v_pk_mul_f32 v[202:203], v[202:203], v[144:145]
    v_pk_fma_f32 v[144:145], v[140:141], v[142:143], v[140:141]
    v_pk_fma_f32 v[204:205], v[54:55], v[142:143], v[54:55]
    v_pk_mul_f32 v[206:207], v[56:57], v[140:141]
    ds_read_b128 v[162:165], v151 offset:3072
    v_smfmac_f32_32x32x32_bf16 v[34:49], v[232:235], v[98:105], v236
    v_cvt_pk_bf16_f32 v74, v200, v201
    v_cvt_pk_bf16_f32 v75, v202, v203
    v_exp_f32 v140, v58
    v_exp_f32 v141, v59
    v_exp_f32 v142, v60
    v_exp_f32 v143, v61
    v_rcp_f32 v144, v144
    v_rcp_f32 v145, v145
    v_pk_add_f32 v[140:141], v[140:141], 1.0 op_sel_hi:[1,0]
    v_pk_mul_f32 v[204:205], v[204:205], v[144:145]
    v_pk_mul_f32 v[206:207], v[206:207], v[144:145]
    v_pk_fma_f32 v[144:145], v[140:141], v[142:143], v[140:141]
    v_pk_fma_f32 v[200:201], v[58:59], v[142:143], v[58:59]
    v_pk_mul_f32 v[202:203], v[60:61], v[140:141]
    s_waitcnt lgkmcnt(1)
    v_mfma_f32_32x32x16_bf16 v[2:17], v[136:139], v[70:73], v[2:17]
    v_cvt_pk_bf16_f32 v76, v204, v205
    v_cvt_pk_bf16_f32 v77, v206, v207
    v_exp_f32 v140, v62
    v_exp_f32 v141, v63
    v_exp_f32 v142, v64
    v_exp_f32 v143, v65
    v_rcp_f32 v144, v144
    v_rcp_f32 v145, v145
    v_pk_add_f32 v[140:141], v[140:141], 1.0 op_sel_hi:[1,0]
    v_pk_mul_f32 v[200:201], v[200:201], v[144:145]
    v_pk_mul_f32 v[202:203], v[202:203], v[144:145]
    v_pk_fma_f32 v[144:145], v[140:141], v[142:143], v[140:141]
    v_pk_fma_f32 v[204:205], v[62:63], v[142:143], v[62:63]
    v_pk_mul_f32 v[206:207], v[64:65], v[140:141]
    s_cmp_eq_u32 s48, 0
    s_cbranch_scc1 K2F_PRIO0
K2F_PRIO0_RET:
    v_mfma_f32_32x32x16_bf16 v[18:33], v[132:135], v[74:77], v[18:33]
    v_cvt_pk_bf16_f32 v78, v200, v201
    v_cvt_pk_bf16_f32 v79, v202, v203
    v_exp_f32 v140, v34
    v_exp_f32 v141, v35
    v_and_b32 v185, s92, v150
    v_exp_f32 v142, v36
    v_exp_f32 v143, v37
    v_rcp_f32 v144, v144
    v_rcp_f32 v145, v145
    v_pk_add_f32 v[140:141], v[140:141], 1.0 op_sel_hi:[1,0]
    v_pk_mul_f32 v[204:205], v[204:205], v[144:145]
    v_pk_mul_f32 v[206:207], v[206:207], v[144:145]
    v_pk_fma_f32 v[144:145], v[140:141], v[142:143], v[140:141]
    v_pk_fma_f32 v[200:201], v[34:35], v[142:143], v[34:35]
    v_pk_mul_f32 v[202:203], v[36:37], v[140:141]
    ds_read_b64_tr_b16 v[132:133], v226 offset:0
    ds_read_b64_tr_b16 v[134:135], v227 offset:0
    ds_read_b128 v[152:155], v173 offset:4352
    ds_read_b128 v[156:159], v173 offset:4368
    v_mfma_f32_32x32x16_bf16 v[50:65], v[128:131], v[120:123], 0
    v_cvt_pk_bf16_f32 v80, v204, v205
    v_cvt_pk_bf16_f32 v81, v206, v207
    v_exp_f32 v140, v38
    v_exp_f32 v141, v39
    v_exp_f32 v142, v40
    v_exp_f32 v143, v41
    v_rcp_f32 v144, v144
    v_rcp_f32 v145, v145
    v_pk_add_f32 v[140:141], v[140:141], 1.0 op_sel_hi:[1,0]
    v_pk_mul_f32 v[200:201], v[200:201], v[144:145]
    v_pk_mul_f32 v[202:203], v[202:203], v[144:145]
    v_pk_fma_f32 v[144:145], v[140:141], v[142:143], v[140:141]
    v_pk_fma_f32 v[204:205], v[38:39], v[142:143], v[38:39]
    v_pk_mul_f32 v[206:207], v[40:41], v[140:141]
    s_waitcnt vmcnt(4) lgkmcnt(4)
    v_dot2_f32_bf16 v166, v174, s31, v162
    v_dot2_f32_bf16 v167, v174, s32, v163
    v_dot2_f32_bf16 v168, v175, s31, v164
    s_cmp_lg_u32 s38, 0
    s_cbranch_scc1 K2F_WXL
K2F_WXL_RET:
    ds_read_b64 v[126:127], v160 offset:528
    ds_read_b64 v[130:131], v160 offset:536
    v_smfmac_f32_32x32x32_bf16 v[50:65], v[232:235], v[106:113], v236
    v_cvt_pk_bf16_f32 v66, v200, v201
    v_cvt_pk_bf16_f32 v67, v202, v203
    v_exp_f32 v140, v42
    v_exp_f32 v141, v43
    v_mov_b32 v129, v150
    v_cvt_pk_bf16_f32 v170, v166, v167
    v_cvt_pk_bf16_f32 v171, v168, 1.0
    v_exp_f32 v142, v44
    v_exp_f32 v143, v45
    v_rcp_f32 v144, v144
    v_rcp_f32 v145, v145
    v_pk_add_f32 v[140:141], v[140:141], 1.0 op_sel_hi:[1,0]
    v_pk_mul_f32 v[204:205], v[204:205], v[144:145]
    v_pk_mul_f32 v[206:207], v[206:207], v[144:145]
    v_pk_fma_f32 v[144:145], v[140:141], v[142:143], v[140:141]
    v_pk_fma_f32 v[200:201], v[42:43], v[142:143], v[42:43]
    v_pk_mul_f32 v[202:203], v[44:45], v[140:141]
    v_dot2_f32_bf16 v169, v171, v171, -1.0
    v_dot2_f32_bf16 v169, v170, v170, v169
    v_dot2_f32_bf16 v166, v175, s91, v165
    s_waitcnt vmcnt(0)
    ds_read_b64_tr_b16 v[82:83], v220 offset:0
    ds_read_b64_tr_b16 v[84:85], v220 offset:512
    ds_read_b64_tr_b16 v[86:87], v220 offset:2048
    ds_read_b64_tr_b16 v[88:89], v220 offset:2560
    ds_read_b64_tr_b16 v[90:91], v221 offset:0
    ds_read_b64_tr_b16 v[92:93], v221 offset:512
    ds_read_b64_tr_b16 v[94:95], v221 offset:2048
    ds_read_b64_tr_b16 v[96:97], v221 offset:2560
    v_cvt_pk_bf16_f32 v128, v169, v169
    v_mfma_f32_32x32x16_bf16 v[18:33], v[136:139], v[78:81], v[18:33]
    v_cvt_pk_bf16_f32 v68, v204, v205
    v_cvt_pk_bf16_f32 v69, v206, v207
    v_exp_f32 v140, v46
    v_exp_f32 v141, v47
    v_exp_f32 v142, v48
    v_exp_f32 v143, v49
    v_rcp_f32 v144, v144
    v_rcp_f32 v145, v145
    v_pk_add_f32 v[140:141], v[140:141], 1.0 op_sel_hi:[1,0]
    v_pk_mul_f32 v[200:201], v[200:201], v[144:145]
    v_pk_mul_f32 v[202:203], v[202:203], v[144:145]
    v_pk_fma_f32 v[144:145], v[140:141], v[142:143], v[140:141]
    v_pk_fma_f32 v[204:205], v[46:47], v[142:143], v[46:47]
    v_pk_mul_f32 v[206:207], v[48:49], v[140:141]
    s_waitcnt lgkmcnt(10)
    v_mad_u32_u16 v152, v152, s30, v216
    v_mad_u32_u16 v154, v154, s30, v216
    v_mad_u32_u16 v156, v156, s30, v216
    v_mad_u32_u16 v158, v158, s30, v216
    ds_read_b64_tr_b16 v[136:137], v226 offset:2048
    ds_read_b64_tr_b16 v[138:139], v227 offset:2048
    ds_write_b64 v172, v[176:177]
    v_mfma_f32_32x32x16_bf16 v[2:17], v[132:135], v[66:69], v[2:17]
    v_cvt_pk_bf16_f32 v70, v200, v201
    v_cvt_pk_bf16_f32 v71, v202, v203
    v_exp_f32 v140, v50
    v_exp_f32 v141, v51
    s_waitcnt lgkmcnt(11)
    v_permlane32_swap_b32 v126, v130
    v_permlane32_swap_b32 v127, v131
    v_xor_b32 v161, v160, v228
    v_cndmask_b32 v172, v241, v161, s[44:45]
    v_exp_f32 v142, v52
    v_exp_f32 v143, v53
    v_rcp_f32 v144, v144
    v_rcp_f32 v145, v145
    v_pk_add_f32 v[140:141], v[140:141], 1.0 op_sel_hi:[1,0]
    v_pk_mul_f32 v[204:205], v[204:205], v[144:145]
    v_pk_mul_f32 v[206:207], v[206:207], v[144:145]
    v_pk_fma_f32 v[144:145], v[140:141], v[142:143], v[140:141]
    v_pk_fma_f32 v[200:201], v[50:51], v[142:143], v[50:51]
    v_pk_mul_f32 v[202:203], v[52:53], v[140:141]
    ds_write_b64 v172, v[170:171]
    s_waitcnt lgkmcnt(4)
    buffer_load_dwordx4 v152, s[12:15], s34 offen offset:0 lds
    buffer_load_dwordx4 v154, s[12:15], s4 offen offset:1024 lds
    buffer_load_dwordx4 v156, s[12:15], s5 offen offset:2048 lds
    buffer_load_dwordx4 v158, s[12:15], s6 offen offset:3072 lds
    v_mfma_f32_32x32x16_bf16 v[34:49], v[126:129], v[116:119], 0
    v_cvt_pk_bf16_f32 v72, v204, v205
    v_cvt_pk_bf16_f32 v73, v206, v207
    v_exp_f32 v140, v54
    v_exp_f32 v141, v55
    v_fmac_f32 v166, s90, v185
    v_fmac_f32 v166, s89, v169
    v_exp_f32 v142, v56
    v_exp_f32 v143, v57
    v_rcp_f32 v144, v144
    v_rcp_f32 v145, v145
    v_pk_add_f32 v[140:141], v[140:141], 1.0 op_sel_hi:[1,0]
    v_pk_mul_f32 v[200:201], v[200:201], v[144:145]
    v_pk_mul_f32 v[202:203], v[202:203], v[144:145]
    v_pk_fma_f32 v[144:145], v[140:141], v[142:143], v[140:141]
    v_pk_fma_f32 v[204:205], v[54:55], v[142:143], v[54:55]
    v_pk_mul_f32 v[206:207], v[56:57], v[140:141]
    v_smfmac_f32_32x32x32_bf16 v[34:49], v[232:235], v[82:89], v236
    v_cvt_pk_bf16_f32 v74, v200, v201
    v_cvt_pk_bf16_f32 v75, v202, v203
    v_exp_f32 v140, v58
    v_exp_f32 v141, v59
    v_cmp_nge_f32 vcc, 0x42700000, v166
    v_exp_f32 v142, v60
    v_exp_f32 v143, v61
    v_rcp_f32 v144, v144
    v_rcp_f32 v145, v145
    v_pk_add_f32 v[140:141], v[140:141], 1.0 op_sel_hi:[1,0]
    v_pk_mul_f32 v[204:205], v[204:205], v[144:145]
    v_pk_mul_f32 v[206:207], v[206:207], v[144:145]
    v_pk_fma_f32 v[144:145], v[140:141], v[142:143], v[140:141]
    v_pk_fma_f32 v[200:201], v[58:59], v[142:143], v[58:59]
    v_pk_mul_f32 v[202:203], v[60:61], v[140:141]
    s_waitcnt lgkmcnt(2)
    v_mfma_f32_32x32x16_bf16 v[2:17], v[136:139], v[70:73], v[2:17]
    v_cvt_pk_bf16_f32 v76, v204, v205
    v_cvt_pk_bf16_f32 v77, v206, v207
    v_exp_f32 v140, v62
    v_exp_f32 v141, v63
    v_exp_f32 v142, v64
    v_exp_f32 v143, v65
    v_rcp_f32 v144, v144
    v_rcp_f32 v145, v145
    v_pk_add_f32 v[140:141], v[140:141], 1.0 op_sel_hi:[1,0]
    v_pk_mul_f32 v[200:201], v[200:201], v[144:145]
    v_pk_mul_f32 v[202:203], v[202:203], v[144:145]
    v_pk_fma_f32 v[144:145], v[140:141], v[142:143], v[140:141]
    v_pk_fma_f32 v[204:205], v[62:63], v[142:143], v[62:63]
    v_pk_mul_f32 v[206:207], v[64:65], v[140:141]
    s_cmp_eq_u32 s48, 0
    s_cbranch_scc1 K2F_DRAIN
    s_cbranch_vccz K2F_LOOP
    ds_write_b64 v172, v[176:177]
    s_lshl_b32 s56, s48, 3
    s_sub_u32 s52, s52, s56
    s_mov_b32 s87, 1
    s_mov_b32 s88, 1
    s_cmp_lg_u32 s39, 0
    s_cbranch_scc1 K2F_DRAIN2
K2F_DRAIN:
    s_mov_b32 s37, s36
K2F_DRAIN2:
    v_mfma_f32_32x32x16_bf16 v[18:33], v[132:135], v[74:77], v[18:33]
    v_rcp_f32 v144, v144
    v_rcp_f32 v145, v145
    v_cvt_pk_bf16_f32 v78, v200, v201
    v_cvt_pk_bf16_f32 v79, v202, v203
    v_mul_f32 v204, v204, v144
    v_mul_f32 v205, v205, v145
    v_mul_f32 v206, v206, v144
    v_mul_f32 v207, v207, v145
    v_cvt_pk_bf16_f32 v80, v204, v205
    v_cvt_pk_bf16_f32 v81, v206, v207
    s_nop 1
K2_LASTM:
    v_mfma_f32_32x32x16_bf16 v[18:33], v[136:139], v[78:81], v[18:33]
    ds_read_b128 v[82:85], v245 offset:2048
    ds_read_b128 v[86:89], v245 offset:3072
    ds_read_b128 v[90:93], v245 offset:6144
    ds_read_b128 v[94:97], v245 offset:7168
    s_mul_i32 s56, s37, 33
    s_lshl_b32 s57, s37, 1
    v_add_u32 v184, s56, v230
    v_add_u32 v185, s57, v231
    v_mul_f32 v190, 0xbf317218, v5
    v_cvt_f64_f32 v[190:191], v190
    ds_add_f64 v184, v[190:191] offset:0
    v_mul_f32 v192, 0xbf317218, v9
    v_cvt_f64_f32 v[192:193], v192
    ds_add_f64 v184, v[192:193] offset:1056
    v_mul_f32 v194, 0xbf317218, v13
    v_cvt_f64_f32 v[194:195], v194
    ds_add_f64 v184, v[194:195] offset:2112
    v_mul_f32 v196, 0xbf317218, v17
    v_cvt_f64_f32 v[196:197], v196
    ds_add_f64 v184, v[196:197] offset:3168
    v_mul_f32 v190, 0xbf317218, v21
    v_cvt_f64_f32 v[190:191], v190
    ds_add_f64 v184, v[190:191] offset:256
    v_mul_f32 v192, 0xbf317218, v25
    v_cvt_f64_f32 v[192:193], v192
    ds_add_f64 v184, v[192:193] offset:1312
    v_mul_f32 v194, 0xbf317218, v29
    v_cvt_f64_f32 v[194:195], v194
    ds_add_f64 v184, v[194:195] offset:2368
    v_mul_f32 v196, 0xbf317218, v33
    v_cvt_f64_f32 v[196:197], v196
    ds_add_f64 v184, v[196:197] offset:3424
    v_pk_mul_f32 v[2:3], v[2:3], v[180:181] op_sel_hi:[1,0]
    v_mul_f32 v4, v4, v180
    v_pk_fma_f32 v[2:3], v[18:19], v[182:183], v[2:3] op_sel_hi:[1,0,1]
    v_fmac_f32 v4, v20, v182
    v_pk_mul_f32 v[6:7], v[6:7], v[180:181] op_sel_hi:[1,0]
    v_mul_f32 v8, v8, v180
    v_pk_fma_f32 v[6:7], v[22:23], v[182:183], v[6:7] op_sel_hi:[1,0,1]
    v_fmac_f32 v8, v24, v182
    v_pk_mul_f32 v[10:11], v[10:11], v[180:181] op_sel_hi:[1,0]
    v_mul_f32 v12, v12, v180
    v_pk_fma_f32 v[10:11], v[26:27], v[182:183], v[10:11] op_sel_hi:[1,0,1]
    v_fmac_f32 v12, v28, v182
    v_pk_mul_f32 v[14:15], v[14:15], v[180:181] op_sel_hi:[1,0]
    v_mul_f32 v16, v16, v180
    v_pk_fma_f32 v[14:15], v[30:31], v[182:183], v[14:15] op_sel_hi:[1,0,1]
    v_fmac_f32 v16, v32, v182
    s_nop 0
    v_permlane16_swap_b32 v2, v10
    v_permlane16_swap_b32 v3, v11
    v_permlane16_swap_b32 v4, v12
    v_permlane16_swap_b32 v6, v14
    v_permlane16_swap_b32 v7, v15
    v_permlane16_swap_b32 v8, v16
    s_nop 0
    v_add_f32 v2, v2, v10
    v_add_f32 v3, v3, v11
    v_add_f32 v4, v4, v12
    v_add_f32 v6, v6, v14
    v_add_f32 v7, v7, v15
    v_add_f32 v8, v8, v16
    v_add_f32_dpp v2, v2, v2 row_ror:8 row_mask:0xf bank_mask:0x3
    v_add_f32_dpp v3, v3, v3 row_ror:8 row_mask:0xf bank_mask:0x3
    v_add_f32_dpp v4, v4, v4 row_ror:8 row_mask:0xf bank_mask:0x3
    v_add_f32_dpp v2, v6, v6 row_ror:8 row_mask:0xf bank_mask:0xc
    v_add_f32_dpp v3, v7, v7 row_ror:8 row_mask:0xf bank_mask:0xc
    v_add_f32_dpp v4, v8, v8 row_ror:8 row_mask:0xf bank_mask:0xc
    v_add_f32_dpp v2, v2, v2 row_half_mirror row_mask:0xf bank_mask:0x5
    s_nop 0
    v_add_f32_dpp v4, v4, v4 row_half_mirror row_mask:0xf bank_mask:0xf
    v_add_f32_dpp v2, v3, v3 row_half_mirror row_mask:0xf bank_mask:0xa
    s_nop 0
    v_add_f32_dpp v4, v4, v4 quad_perm:[1,0,3,2] row_mask:0xf bank_mask:0xf
    v_add_f32_dpp v2, v2, v2 quad_perm:[1,0,3,2] row_mask:0xf bank_mask:0xf
    s_nop 0
    v_add_f32_dpp v4, v4, v4 quad_perm:[2,3,0,1] row_mask:0xf bank_mask:0xf
    v_add_f32_dpp v2, v2, v2 quad_perm:[2,3,0,1] row_mask:0xf bank_mask:0xf
    v_cndmask_b32 v2, v2, v4, s[74:75]
    v_cvt_f64_f32 v[198:199], v2
    s_mov_b64 exec, s[72:73]
    ds_add_f64 v185, v[198:199] offset:1328
    s_mov_b64 exec, -1
    s_cmp_lg_u32 s88, 0
    s_cbranch_scc1 K2_REFILL
K2_WDONE:
    s_cmp_lg_u32 s53, 0
    s_cbranch_scc1 K2_MORE
    s_mov_b32 s59, 0xffff0000
    s_cmp_lt_u32 s3, 4
    s_cbranch_scc1 K2_HLO
    v_lshlrev_b32 v34, 16, v212
    v_and_b32 v35, s59, v212
    v_lshlrev_b32 v36, 16, v213
    v_and_b32 v37, s59, v213
    v_lshlrev_b32 v38, 16, v214
    v_and_b32 v39, s59, v214
    v_lshlrev_b32 v40, 16, v215
    v_and_b32 v41, s59, v215
    s_branch K2_HOK
K2_HLO:
    v_lshlrev_b32 v34, 16, v208
    v_and_b32 v35, s59, v208
    v_lshlrev_b32 v36, 16, v209
    v_and_b32 v37, s59, v209
    v_lshlrev_b32 v38, 16, v210
    v_and_b32 v39, s59, v210
    v_lshlrev_b32 v40, 16, v211
    v_and_b32 v41, s59, v211
K2_HOK:
    s_waitcnt lgkmcnt(0)
    s_barrier
    ds_read_b128 v[50:53], v244 offset:0
    ds_read_b128 v[54:57], v244 offset:16
    ds_read_b128 v[58:61], v244 offset:32
    ds_read_b128 v[62:65], v244 offset:48
    ds_read_b128 v[18:21], v244 offset:256
    ds_read_b128 v[22:25], v244 offset:272
    ds_read_b128 v[26:29], v244 offset:288
    ds_read_b128 v[30:33], v244 offset:304
    ds_read_b32 v167, v242 offset:3072
    ds_read_b64 v[174:175], v243 offset:1328
    s_waitcnt lgkmcnt(9)
    v_cvt_f32_f64 v50, v[50:51]
    v_cvt_f32_f64 v51, v[52:53]
    v_cvt_pk_bf16_f32 v66, v50, v51
    s_waitcnt lgkmcnt(8)
    v_cvt_f32_f64 v54, v[54:55]
    v_cvt_f32_f64 v55, v[56:57]
    v_cvt_pk_bf16_f32 v67, v54, v55
    s_waitcnt lgkmcnt(7)
    v_cvt_f32_f64 v58, v[58:59]
    v_cvt_f32_f64 v59, v[60:61]
    v_cvt_pk_bf16_f32 v68, v58, v59
    s_waitcnt lgkmcnt(6)
    v_cvt_f32_f64 v62, v[62:63]
    v_cvt_f32_f64 v63, v[64:65]
    v_cvt_pk_bf16_f32 v69, v62, v63
    s_nop 1
    v_mfma_f32_16x16x32_bf16 v[248:251], v[82:85], v[66:69], v[248:251]
    v_mfma_f32_16x16x32_bf16 v[252:255], v[90:93], v[66:69], v[252:255]
    s_waitcnt lgkmcnt(5)
    v_cvt_f32_f64 v18, v[18:19]
    v_cvt_f32_f64 v19, v[20:21]
    v_cvt_pk_bf16_f32 v70, v18, v19
    s_waitcnt lgkmcnt(4)
    v_cvt_f32_f64 v22, v[22:23]
    v_cvt_f32_f64 v23, v[24:25]
    v_cvt_pk_bf16_f32 v71, v22, v23
    s_waitcnt lgkmcnt(3)
    v_cvt_f32_f64 v26, v[26:27]
    v_cvt_f32_f64 v27, v[28:29]
    v_cvt_pk_bf16_f32 v72, v26, v27
    s_waitcnt lgkmcnt(2)
    v_cvt_f32_f64 v30, v[30:31]
    v_cvt_f32_f64 v31, v[32:33]
    v_cvt_pk_bf16_f32 v73, v30, v31
    s_nop 1
    v_mfma_f32_16x16x32_bf16 v[248:251], v[86:89], v[70:73], v[248:251]
    v_mfma_f32_16x16x32_bf16 v[252:255], v[94:97], v[70:73], v[252:255]
    v_mov_b32 v170, 0xbfb8aa3b
    s_mov_b64 exec, s[84:85]
    s_cbranch_execz K2_NOPOS
    s_waitcnt lgkmcnt(0)
    v_cvt_f32_f64 v168, v[174:175]
    v_lshlrev_b32 v162, 1, v0
    v_add_f32 v167, v167, v168
    v_cvt_pk_bf16_f32 v167, v167, v167
    buffer_store_short v167, v162, s[20:23], s80 offen sc1
K2_NOPOS:
    s_mov_b64 exec, -1
    s_nop 4
    v_pk_mul_f32 v[42:43], v[248:249], v[170:171] op_sel_hi:[1,0]
    v_pk_mul_f32 v[44:45], v[250:251], v[170:171] op_sel_hi:[1,0]
    v_pk_mul_f32 v[46:47], v[252:253], v[170:171] op_sel_hi:[1,0]
    v_pk_mul_f32 v[48:49], v[254:255], v[170:171] op_sel_hi:[1,0]
    v_exp_f32 v42, v42
    v_exp_f32 v43, v43
    v_exp_f32 v44, v44
    v_exp_f32 v45, v45
    v_exp_f32 v46, v46
    v_exp_f32 v47, v47
    v_exp_f32 v48, v48
    v_exp_f32 v49, v49
    v_pk_add_f32 v[42:43], v[42:43], 1.0 op_sel_hi:[1,0]
    v_pk_add_f32 v[44:45], v[44:45], 1.0 op_sel_hi:[1,0]
    v_pk_add_f32 v[46:47], v[46:47], 1.0 op_sel_hi:[1,0]
    v_pk_add_f32 v[48:49], v[48:49], 1.0 op_sel_hi:[1,0]
    v_rcp_f32 v42, v42
    v_rcp_f32 v43, v43
    v_rcp_f32 v44, v44
    v_rcp_f32 v45, v45
    v_rcp_f32 v46, v46
    v_rcp_f32 v47, v47
    v_rcp_f32 v48, v48
    v_rcp_f32 v49, v49
    v_pk_fma_f32 v[34:35], v[42:43], v[248:249], v[34:35]
    v_pk_fma_f32 v[36:37], v[44:45], v[250:251], v[36:37]
    v_pk_fma_f32 v[38:39], v[46:47], v[252:253], v[38:39]
    v_pk_fma_f32 v[40:41], v[48:49], v[254:255], v[40:41]
    v_cvt_pk_bf16_f32 v42, v34, v35
    v_cvt_pk_bf16_f32 v43, v36, v37
    v_cvt_pk_bf16_f32 v44, v38, v39
    v_cvt_pk_bf16_f32 v45, v40, v41
    s_mov_b64 exec, s[82:83]
    s_cbranch_execz K2_END
    buffer_store_dwordx4 v[42:45], v247, s[20:23], s81 offen sc1
K2_END:
    s_endpgm
K2_NOWORK:
    s_cmp_eq_u32 s86, 0
    s_cbranch_scc1 K2_NOEP2
    s_lshr_b32 s56, s3, 2
    s_lshl_b32 s56, s56, 13
    s_add_u32 s56, s56, 54784
    v_lshl_add_u32 v185, v241, 1, s56
    ds_read_b128 v[208:211], v245
    ds_read_b128 v[212:215], v246
    ds_read_b128 v[98:101], v185 offset:0
    ds_read_b128 v[102:105], v185 offset:1024
    ds_read_b128 v[106:109], v185 offset:4096
    ds_read_b128 v[110:113], v185 offset:5120
    v_mov_b32 v245, v185
    s_mov_b32 s86, 0
    v_mul_u32_u24 v242, 21846, v0
    s_mul_i32 s80, s28, 6
    s_add_u32 s80, s80, 1600000
    v_add_u32_sdwa v242, v242, v0 dst_sel:DWORD dst_unused:UNUSED_PAD src0_sel:WORD_1 src1_sel:DWORD
    s_mul_i32 s57, s29, 3
    v_cmp_gt_u32 s[84:85], s57, v0
    v_lshlrev_b32 v243, 3, v242
    v_lshlrev_b32 v242, 2, v242
    s_and_b32 s56, s3, 3
    s_lshl_b32 s56, s56, 4
    s_sub_i32 s57, s29, s56
    s_lshl_b32 s57, s57, 7
    v_cmp_gt_i32 s[82:83], s57, v247
    s_add_u32 s56, s56, s28
    s_lshl_b32 s56, s56, 7
    s_lshr_b32 s57, s3, 2
    s_lshl_b32 s57, s57, 6
    s_add_u32 s81, s56, s57
    s_waitcnt lgkmcnt(0)
    v_mfma_f32_16x16x32_bf16 v[248:251], v[98:101], v[208:211], 0
    v_mfma_f32_16x16x32_bf16 v[252:255], v[106:109], v[208:211], 0
    v_mfma_f32_16x16x32_bf16 v[248:251], v[102:105], v[212:215], v[248:251]
    v_mfma_f32_16x16x32_bf16 v[252:255], v[110:113], v[212:215], v[252:255]
K2_NOEP2:
    ds_read_b128 v[82:85], v245 offset:2048
    ds_read_b128 v[86:89], v245 offset:3072
    ds_read_b128 v[90:93], v245 offset:6144
    ds_read_b128 v[94:97], v245 offset:7168
    s_branch K2_WDONE
K2F_FLUSH:
    s_mul_i32 s56, s37, 33
    s_lshl_b32 s57, s37, 1
    v_add_u32 v184, s56, v230
    v_add_u32 v185, s57, v231
    v_mul_f32 v190, 0xbf317218, v5
    v_cvt_f64_f32 v[190:191], v190
    ds_add_f64 v184, v[190:191] offset:0
    v_mul_f32 v192, 0xbf317218, v9
    v_cvt_f64_f32 v[192:193], v192
    ds_add_f64 v184, v[192:193] offset:1056
    v_mul_f32 v194, 0xbf317218, v13
    v_cvt_f64_f32 v[194:195], v194
    ds_add_f64 v184, v[194:195] offset:2112
    v_mul_f32 v196, 0xbf317218, v17
    v_cvt_f64_f32 v[196:197], v196
    ds_add_f64 v184, v[196:197] offset:3168
    v_mul_f32 v190, 0xbf317218, v21
    v_cvt_f64_f32 v[190:191], v190
    ds_add_f64 v184, v[190:191] offset:256
    v_mul_f32 v192, 0xbf317218, v25
    v_cvt_f64_f32 v[192:193], v192
    ds_add_f64 v184, v[192:193] offset:1312
    v_mul_f32 v194, 0xbf317218, v29
    v_cvt_f64_f32 v[194:195], v194
    ds_add_f64 v184, v[194:195] offset:2368
    v_mul_f32 v196, 0xbf317218, v33
    v_cvt_f64_f32 v[196:197], v196
    ds_add_f64 v184, v[196:197] offset:3424
    v_pk_mul_f32 v[2:3], v[2:3], v[180:181] op_sel_hi:[1,0]
    v_mul_f32 v4, v4, v180
    v_pk_fma_f32 v[2:3], v[18:19], v[182:183], v[2:3] op_sel_hi:[1,0,1]
    v_fmac_f32 v4, v20, v182
    v_pk_mul_f32 v[6:7], v[6:7], v[180:181] op_sel_hi:[1,0]
    v_mul_f32 v8, v8, v180
    v_pk_fma_f32 v[6:7], v[22:23], v[182:183], v[6:7] op_sel_hi:[1,0,1]
    v_fmac_f32 v8, v24, v182
    v_pk_mul_f32 v[10:11], v[10:11], v[180:181] op_sel_hi:[1,0]
    v_mul_f32 v12, v12, v180
    v_pk_fma_f32 v[10:11], v[26:27], v[182:183], v[10:11] op_sel_hi:[1,0,1]
    v_fmac_f32 v12, v28, v182
    v_pk_mul_f32 v[14:15], v[14:15], v[180:181] op_sel_hi:[1,0]
    v_mul_f32 v16, v16, v180
    v_pk_fma_f32 v[14:15], v[30:31], v[182:183], v[14:15] op_sel_hi:[1,0,1]
    v_fmac_f32 v16, v32, v182
    v_mfma_f32_32x32x16_bf16 v[18:33], v[176:179], v[176:179], 0
    v_permlane16_swap_b32 v2, v10
    v_permlane16_swap_b32 v3, v11
    v_permlane16_swap_b32 v4, v12
    v_permlane16_swap_b32 v6, v14
    v_permlane16_swap_b32 v7, v15
    v_permlane16_swap_b32 v8, v16
    s_nop 0
    v_add_f32 v2, v2, v10
    v_add_f32 v3, v3, v11
    v_add_f32 v4, v4, v12
    v_add_f32 v6, v6, v14
    v_add_f32 v7, v7, v15
    v_add_f32 v8, v8, v16
    v_add_f32_dpp v2, v2, v2 row_ror:8 row_mask:0xf bank_mask:0x3
    v_add_f32_dpp v3, v3, v3 row_ror:8 row_mask:0xf bank_mask:0x3
    v_add_f32_dpp v4, v4, v4 row_ror:8 row_mask:0xf bank_mask:0x3
    v_add_f32_dpp v2, v6, v6 row_ror:8 row_mask:0xf bank_mask:0xc
    v_add_f32_dpp v3, v7, v7 row_ror:8 row_mask:0xf bank_mask:0xc
    v_add_f32_dpp v4, v8, v8 row_ror:8 row_mask:0xf bank_mask:0xc
    v_add_f32_dpp v2, v2, v2 row_half_mirror row_mask:0xf bank_mask:0x5
    s_nop 0
    v_add_f32_dpp v4, v4, v4 row_half_mirror row_mask:0xf bank_mask:0xf
    v_add_f32_dpp v2, v3, v3 row_half_mirror row_mask:0xf bank_mask:0xa
    s_nop 0
    v_add_f32_dpp v4, v4, v4 quad_perm:[1,0,3,2] row_mask:0xf bank_mask:0xf
    v_add_f32_dpp v2, v2, v2 quad_perm:[1,0,3,2] row_mask:0xf bank_mask:0xf
    s_nop 0
    v_add_f32_dpp v4, v4, v4 quad_perm:[2,3,0,1] row_mask:0xf bank_mask:0xf
    v_add_f32_dpp v2, v2, v2 quad_perm:[2,3,0,1] row_mask:0xf bank_mask:0xf
    v_cndmask_b32 v2, v2, v4, s[74:75]
    v_cvt_f64_f32 v[198:199], v2
    s_mov_b64 exec, s[72:73]
    ds_add_f64 v185, v[198:199] offset:1328
    s_mov_b64 exec, -1
    v_mfma_f32_32x32x16_bf16 v[2:17], v[176:179], v[176:179], 0
    s_mov_b32 s39, 0
    s_branch K2F_FLUSH_RET
K2F_REBASE:
    s_mov_b32 s37, s36
    v_readfirstlane_b32 s36, v151
    s_mov_b32 s38, 1
    s_mov_b32 s39, 1
    s_min_u32 s36, s36, 656
    v_subrev_u32 v160, s36, v151
    v_cmp_gt_u32 vcc, s30, v160
    s_and_b64 s[44:45], vcc, s[46:47]
    s_branch K2F_REBASE_RET
K2F_WXL:
    s_mul_i32 s56, s36, 9
    v_add_u32 v184, s56, v240
    ds_read_b64_tr_b16 v[116:117], v184
    ds_read_b64_tr_b16 v[122:123], v184 offset:64
    s_mov_b32 s38, 0
    s_branch K2F_WXL_RET
K2F_PRIO:
    s_cmp_gt_i32 s40, 0
    s_cbranch_scc0 K2F_PRIO1
    s_setprio 2
    s_mov_b32 s41, 0
    s_branch K2F_PRIO_RET
K2F_PRIO1:
    s_setprio 1
    s_branch K2F_PRIO_RET
K2F_PRIO0:
    s_setprio 0
    s_cmp_gt_u32 s43, 32
    s_cbranch_scc1 K2F_PRIO0_RET
    ds_write_b64 v172, v[176:177]
    s_branch K2F_DRAIN
K2S_FLUSH:
    s_mul_i32 s56, s37, 33
    s_lshl_b32 s57, s37, 1
    v_add_u32 v184, s56, v230
    v_add_u32 v185, s57, v231
    v_mul_f32 v190, 0xbf317218, v5
    v_cvt_f64_f32 v[190:191], v190
    ds_add_f64 v184, v[190:191] offset:0
    v_mul_f32 v192, 0xbf317218, v9
    v_cvt_f64_f32 v[192:193], v192
    ds_add_f64 v184, v[192:193] offset:1056
    v_mul_f32 v194, 0xbf317218, v13
    v_cvt_f64_f32 v[194:195], v194
    ds_add_f64 v184, v[194:195] offset:2112
    v_mul_f32 v196, 0xbf317218, v17
    v_cvt_f64_f32 v[196:197], v196
    ds_add_f64 v184, v[196:197] offset:3168
    v_mul_f32 v190, 0xbf317218, v21
    v_cvt_f64_f32 v[190:191], v190
    ds_add_f64 v184, v[190:191] offset:256
    v_mul_f32 v192, 0xbf317218, v25
    v_cvt_f64_f32 v[192:193], v192
    ds_add_f64 v184, v[192:193] offset:1312
    v_mul_f32 v194, 0xbf317218, v29
    v_cvt_f64_f32 v[194:195], v194
    ds_add_f64 v184, v[194:195] offset:2368
    v_mul_f32 v196, 0xbf317218, v33
    v_cvt_f64_f32 v[196:197], v196
    ds_add_f64 v184, v[196:197] offset:3424
    v_pk_mul_f32 v[2:3], v[2:3], v[180:181] op_sel_hi:[1,0]
    v_mul_f32 v4, v4, v180
    v_pk_fma_f32 v[2:3], v[18:19], v[182:183], v[2:3] op_sel_hi:[1,0,1]
    v_fmac_f32 v4, v20, v182
    v_pk_mul_f32 v[6:7], v[6:7], v[180:181] op_sel_hi:[1,0]
    v_mul_f32 v8, v8, v180
    v_pk_fma_f32 v[6:7], v[22:23], v[182:183], v[6:7] op_sel_hi:[1,0,1]
    v_fmac_f32 v8, v24, v182
    v_pk_mul_f32 v[10:11], v[10:11], v[180:181] op_sel_hi:[1,0]
    v_mul_f32 v12, v12, v180
    v_pk_fma_f32 v[10:11], v[26:27], v[182:183], v[10:11] op_sel_hi:[1,0,1]
    v_fmac_f32 v12, v28, v182
    v_pk_mul_f32 v[14:15], v[14:15], v[180:181] op_sel_hi:[1,0]
    v_mul_f32 v16, v16, v180
    v_pk_fma_f32 v[14:15], v[30:31], v[182:183], v[14:15] op_sel_hi:[1,0,1]
    v_fmac_f32 v16, v32, v182
    v_mfma_f32_32x32x16_bf16 v[18:33], v[176:179], v[176:179], 0
    v_permlane16_swap_b32 v2, v10
    v_permlane16_swap_b32 v3, v11
    v_permlane16_swap_b32 v4, v12
    v_permlane16_swap_b32 v6, v14
    v_permlane16_swap_b32 v7, v15
    v_permlane16_swap_b32 v8, v16
    s_nop 0
    v_add_f32 v2, v2, v10
    v_add_f32 v3, v3, v11
    v_add_f32 v4, v4, v12
    v_add_f32 v6, v6, v14
    v_add_f32 v7, v7, v15
    v_add_f32 v8, v8, v16
    v_add_f32_dpp v2, v2, v2 row_ror:8 row_mask:0xf bank_mask:0x3
    v_add_f32_dpp v3, v3, v3 row_ror:8 row_mask:0xf bank_mask:0x3
    v_add_f32_dpp v4, v4, v4 row_ror:8 row_mask:0xf bank_mask:0x3
    v_add_f32_dpp v2, v6, v6 row_ror:8 row_mask:0xf bank_mask:0xc
    v_add_f32_dpp v3, v7, v7 row_ror:8 row_mask:0xf bank_mask:0xc
    v_add_f32_dpp v4, v8, v8 row_ror:8 row_mask:0xf bank_mask:0xc
    v_add_f32_dpp v2, v2, v2 row_half_mirror row_mask:0xf bank_mask:0x5
    s_nop 0
    v_add_f32_dpp v4, v4, v4 row_half_mirror row_mask:0xf bank_mask:0xf
    v_add_f32_dpp v2, v3, v3 row_half_mirror row_mask:0xf bank_mask:0xa
    s_nop 0
    v_add_f32_dpp v4, v4, v4 quad_perm:[1,0,3,2] row_mask:0xf bank_mask:0xf
    v_add_f32_dpp v2, v2, v2 quad_perm:[1,0,3,2] row_mask:0xf bank_mask:0xf
    s_nop 0
    v_add_f32_dpp v4, v4, v4 quad_perm:[2,3,0,1] row_mask:0xf bank_mask:0xf
    v_add_f32_dpp v2, v2, v2 quad_perm:[2,3,0,1] row_mask:0xf bank_mask:0xf
    v_cndmask_b32 v2, v2, v4, s[74:75]
    v_cvt_f64_f32 v[198:199], v2
    s_mov_b64 exec, s[72:73]
    ds_add_f64 v185, v[198:199] offset:1328
    s_mov_b64 exec, -1
    v_mfma_f32_32x32x16_bf16 v[2:17], v[176:179], v[176:179], 0
    s_mov_b32 s39, 0
    s_branch K2S_FLUSH_RET
K2S_REBASE:
    s_mov_b32 s37, s36
    v_readfirstlane_b32 s36, v151
    s_mov_b32 s38, 1
    s_mov_b32 s39, 1
    s_min_u32 s36, s36, 656
    v_subrev_u32 v160, s36, v151
    v_cmp_gt_u32 vcc, s30, v160
    s_and_b64 s[44:45], vcc, s[46:47]
    s_branch K2S_REBASE_RET
K2S_WXL:
    s_mul_i32 s56, s36, 9
    v_add_u32 v184, s56, v240
    ds_read_b64_tr_b16 v[116:117], v184
    ds_read_b64_tr_b16 v[122:123], v184 offset:64
    s_mov_b32 s38, 0
    s_branch K2S_WXL_RET
K2S_PRIO:
    s_cmp_gt_i32 s40, 0
    s_cbranch_scc0 K2S_PRIO1
    s_setprio 2
    s_mov_b32 s41, 0
    s_branch K2S_PRIO_RET
K2S_PRIO1:
    s_setprio 1
    s_branch K2S_PRIO_RET
K2S_PRIO0:
    s_setprio 0
    s_cmp_gt_u32 s43, 32
    s_cbranch_scc1 K2S_PRIO0_RET
    ds_write_b64 v172, v[176:177]
    s_branch K2S_DRAIN
K2_REFILL:
    s_mov_b32 s88, 0
    s_mov_b64 s[38:39], 0
    s_waitcnt vmcnt(0) lgkmcnt(0)
    v_add_u32 v161, s52, v241
    v_add_u32 v173, s52, v229
    v_mfma_f32_32x32x16_bf16 v[2:17], v[176:179], v[176:179], 0
    v_mfma_f32_32x32x16_bf16 v[18:33], v[176:179], v[176:179], 0
    s_sub_u32 s40, s35, s52
    v_cmp_gt_i32 s[46:47], s40, v241
    v_mfma_f32_32x32x16_bf16 v[132:147], v[176:179], v[176:179], 0
    s_nop 7
    s_branch K2_FILL
    .p2align 6
K2S_LOOP:
    s_sub_u32 s40, s35, s52
    s_cmp_le_i32 s40, s41
    s_cbranch_scc1 K2S_PRIO
K2S_PRIO_RET:
    v_mfma_f32_32x32x16_bf16 v[18:33], v[132:135], v[74:77], v[18:33]
    v_cvt_pk_bf16_f32 v80, v144, v145
    v_exp_f32 v140, v34
    v_exp_f32 v141, v35
    v_rcp_f32 v146, v146
    v_rcp_f32 v147, v147
    v_pk_add_f32 v[140:141], v[140:141], 1.0 op_sel_hi:[1,0]
    v_pk_mul_f32 v[146:147], v[146:147], v[64:65]
    v_mfma_f32_32x32x16_bf16 v[50:65], v[126:129], v[122:125], 0
    v_cvt_pk_bf16_f32 v81, v146, v147
    v_exp_f32 v142, v36
    v_exp_f32 v143, v37
    v_rcp_f32 v140, v140
    v_rcp_f32 v141, v141
    v_pk_add_f32 v[142:143], v[142:143], 1.0 op_sel_hi:[1,0]
    v_pk_mul_f32 v[140:141], v[140:141], v[34:35]
    v_mfma_f32_32x32x16_bf16 v[18:33], v[136:139], v[78:81], v[18:33]
    v_cvt_pk_bf16_f32 v66, v140, v141
    v_exp_f32 v144, v38
    v_exp_f32 v145, v39
    v_rcp_f32 v142, v142
    v_rcp_f32 v143, v143
    v_pk_add_f32 v[144:145], v[144:145], 1.0 op_sel_hi:[1,0]
    v_pk_mul_f32 v[142:143], v[142:143], v[36:37]
    ds_read_b64_tr_b16 v[132:133], v224 offset:0
    ds_read_b64_tr_b16 v[134:135], v225 offset:0
    ds_read_b64_tr_b16 v[136:137], v224 offset:2048
    ds_read_b64_tr_b16 v[138:139], v225 offset:2048
    v_cvt_pk_bf16_f32 v67, v142, v143
    v_exp_f32 v146, v40
    v_exp_f32 v147, v41
    v_rcp_f32 v144, v144
    v_rcp_f32 v145, v145
    v_pk_add_f32 v[146:147], v[146:147], 1.0 op_sel_hi:[1,0]
    v_pk_mul_f32 v[144:145], v[144:145], v[38:39]
    v_add_u32 v161, s52, v241
    ds_read_b64 v[150:151], v161 offset:4096
    v_add_u32 v173, s52, v229
    ds_read_b128 v[152:155], v173 offset:4096
    ds_read_b128 v[156:159], v173 offset:4112
    v_smfmac_f32_32x32x32_bf16 v[50:65], v[232:235], v[90:97], v236
    v_cvt_pk_bf16_f32 v68, v144, v145
    v_exp_f32 v140, v42
    v_exp_f32 v141, v43
    v_rcp_f32 v146, v146
    v_rcp_f32 v147, v147
    v_pk_add_f32 v[140:141], v[140:141], 1.0 op_sel_hi:[1,0]
    v_pk_mul_f32 v[146:147], v[146:147], v[40:41]
    s_cmp_lg_u32 s39, 0
    s_cbranch_scc1 K2S_FLUSH
K2S_FLUSH_RET:
    v_cvt_pk_bf16_f32 v69, v146, v147
    v_exp_f32 v142, v44
    v_exp_f32 v143, v45
    v_rcp_f32 v140, v140
    v_rcp_f32 v141, v141
    v_pk_add_f32 v[142:143], v[142:143], 1.0 op_sel_hi:[1,0]
    v_pk_mul_f32 v[140:141], v[140:141], v[42:43]
    s_waitcnt lgkmcnt(2) vmcnt(0)
    ds_read_b64_tr_b16 v[98:99], v220 offset:0
    ds_read_b64_tr_b16 v[100:101], v220 offset:512
    ds_read_b64_tr_b16 v[102:103], v220 offset:2048
    ds_read_b64_tr_b16 v[104:105], v220 offset:2560
    ds_read_b64_tr_b16 v[106:107], v221 offset:0
    ds_read_b64_tr_b16 v[108:109], v221 offset:512
    ds_read_b64_tr_b16 v[110:111], v221 offset:2048
    ds_read_b64_tr_b16 v[112:113], v221 offset:2560
    v_mad_u32_u16 v161, v150, 8, 0
    buffer_load_dwordx2 v[174:175], v161, s[12:15], s33 offen
    v_cvt_pk_bf16_f32 v70, v140, v141
    v_exp_f32 v144, v46
    v_exp_f32 v145, v47
    v_rcp_f32 v142, v142
    v_rcp_f32 v143, v143
    v_pk_add_f32 v[144:145], v[144:145], 1.0 op_sel_hi:[1,0]
    v_pk_mul_f32 v[142:143], v[142:143], v[44:45]
    s_waitcnt lgkmcnt(8)
    v_mad_u32_u16 v152, v152, s30, v216
    v_mad_u32_u16 v154, v154, s30, v216
    v_mad_u32_u16 v156, v156, s30, v216
    v_mad_u32_u16 v158, v158, s30, v216
    v_cvt_pk_bf16_f32 v71, v142, v143
    v_exp_f32 v146, v48
    v_exp_f32 v147, v49
    v_rcp_f32 v144, v144
    v_rcp_f32 v145, v145
    v_pk_add_f32 v[146:147], v[146:147], 1.0 op_sel_hi:[1,0]
    v_pk_mul_f32 v[144:145], v[144:145], v[46:47]
    v_subrev_u32 v160, s36, v151
    v_cmp_gt_i32 s[46:47], s40, v241
    v_cmp_gt_u32 vcc, s30, v160
    v_mfma_f32_32x32x16_bf16 v[2:17], v[132:135], v[66:69], v[2:17]
    v_cvt_pk_bf16_f32 v72, v144, v145
    v_exp_f32 v140, v50
    v_exp_f32 v141, v51
    v_rcp_f32 v146, v146
    v_rcp_f32 v147, v147
    v_pk_add_f32 v[140:141], v[140:141], 1.0 op_sel_hi:[1,0]
    v_pk_mul_f32 v[146:147], v[146:147], v[48:49]
    s_and_b64 s[44:45], vcc, s[46:47]
    s_cmp_lg_u64 s[44:45], s[46:47]
    s_cbranch_scc1 K2S_REBASE
K2S_REBASE_RET:
    s_mov_b32 s43, s48
    s_bcnt1_i32_b64 s48, s[44:45]
    s_lshl3_add_u32 s52, s48, s52
    s_waitcnt lgkmcnt(0)
    buffer_load_dwordx4 v152, s[12:15], s34 offen offset:0 lds
    buffer_load_dwordx4 v154, s[12:15], s4 offen offset:1024 lds
    buffer_load_dwordx4 v156, s[12:15], s5 offen offset:2048 lds
    buffer_load_dwordx4 v158, s[12:15], s6 offen offset:3072 lds
    v_mfma_f32_32x32x16_bf16 v[34:49], v[128:131], v[114:117], 0
    v_cvt_pk_bf16_f32 v73, v146, v147
    v_exp_f32 v142, v52
    v_exp_f32 v143, v53
    v_rcp_f32 v140, v140
    v_rcp_f32 v141, v141
    v_pk_add_f32 v[142:143], v[142:143], 1.0 op_sel_hi:[1,0]
    v_pk_mul_f32 v[140:141], v[140:141], v[50:51]
    ds_read_b128 v[162:165], v151 offset:3072
    v_mfma_f32_32x32x16_bf16 v[2:17], v[136:139], v[70:73], v[2:17]
    v_cvt_pk_bf16_f32 v74, v140, v141
    v_exp_f32 v144, v54
    v_exp_f32 v145, v55
    v_rcp_f32 v142, v142
    v_rcp_f32 v143, v143
    v_pk_add_f32 v[144:145], v[144:145], 1.0 op_sel_hi:[1,0]
    v_pk_mul_f32 v[142:143], v[142:143], v[52:53]
    v_cvt_pk_bf16_f32 v75, v142, v143
    v_exp_f32 v146, v56
    v_exp_f32 v147, v57
    v_rcp_f32 v144, v144
    v_rcp_f32 v145, v145
    v_pk_add_f32 v[146:147], v[146:147], 1.0 op_sel_hi:[1,0]
    v_pk_mul_f32 v[144:145], v[144:145], v[54:55]
    v_smfmac_f32_32x32x32_bf16 v[34:49], v[232:235], v[98:105], v236
    v_cvt_pk_bf16_f32 v76, v144, v145
    v_exp_f32 v140, v58
    v_exp_f32 v141, v59
    v_rcp_f32 v146, v146
    v_rcp_f32 v147, v147
    v_pk_add_f32 v[140:141], v[140:141], 1.0 op_sel_hi:[1,0]
    v_pk_mul_f32 v[146:147], v[146:147], v[56:57]
    v_cvt_pk_bf16_f32 v77, v146, v147
    v_exp_f32 v142, v60
    v_exp_f32 v143, v61
    v_rcp_f32 v140, v140
    v_rcp_f32 v141, v141
    v_pk_add_f32 v[142:143], v[142:143], 1.0 op_sel_hi:[1,0]
    v_pk_mul_f32 v[140:141], v[140:141], v[58:59]
    v_cvt_pk_bf16_f32 v78, v140, v141
    v_exp_f32 v144, v62
    v_exp_f32 v145, v63
    v_rcp_f32 v142, v142
    v_rcp_f32 v143, v143
    v_pk_add_f32 v[144:145], v[144:145], 1.0 op_sel_hi:[1,0]
    v_pk_mul_f32 v[142:143], v[142:143], v[60:61]
    v_cvt_pk_bf16_f32 v79, v142, v143
    v_exp_f32 v146, v64
    v_exp_f32 v147, v65
    v_rcp_f32 v144, v144
    v_rcp_f32 v145, v145
    v_pk_add_f32 v[146:147], v[146:147], 1.0 op_sel_hi:[1,0]
    v_pk_mul_f32 v[144:145], v[144:145], v[62:63]
    s_cmp_eq_u32 s48, 0
    s_cbranch_scc1 K2S_PRIO0
K2S_PRIO0_RET:
    v_mfma_f32_32x32x16_bf16 v[18:33], v[132:135], v[74:77], v[18:33]
    v_cvt_pk_bf16_f32 v80, v144, v145
    v_exp_f32 v140, v34
    v_exp_f32 v141, v35
    v_rcp_f32 v146, v146
    v_rcp_f32 v147, v147
    v_pk_add_f32 v[140:141], v[140:141], 1.0 op_sel_hi:[1,0]
    v_pk_mul_f32 v[146:147], v[146:147], v[64:65]
    v_mfma_f32_32x32x16_bf16 v[50:65], v[128:131], v[120:123], 0
    v_cvt_pk_bf16_f32 v81, v146, v147
    v_exp_f32 v142, v36
    v_exp_f32 v143, v37
    v_rcp_f32 v140, v140
    v_rcp_f32 v141, v141
    v_pk_add_f32 v[142:143], v[142:143], 1.0 op_sel_hi:[1,0]
    v_pk_mul_f32 v[140:141], v[140:141], v[34:35]
    s_cmp_lg_u32 s38, 0
    s_cbranch_scc1 K2S_WXL
K2S_WXL_RET:
    ds_read_b64 v[126:127], v160 offset:528
    ds_read_b64 v[130:131], v160 offset:536
    v_mov_b32 v129, v150
    v_mfma_f32_32x32x16_bf16 v[18:33], v[136:139], v[78:81], v[18:33]
    v_cvt_pk_bf16_f32 v66, v140, v141
    v_exp_f32 v144, v38
    v_exp_f32 v145, v39
    v_rcp_f32 v142, v142
    v_rcp_f32 v143, v143
    v_pk_add_f32 v[144:145], v[144:145], 1.0 op_sel_hi:[1,0]
    v_pk_mul_f32 v[142:143], v[142:143], v[36:37]
    s_waitcnt vmcnt(4) lgkmcnt(2)
    v_dot2_f32_bf16 v166, v174, s31, v162
    v_dot2_f32_bf16 v167, v174, s32, v163
    v_dot2_f32_bf16 v168, v175, s31, v164
    ds_read_b64_tr_b16 v[132:133], v226 offset:0
    ds_read_b64_tr_b16 v[134:135], v227 offset:0
    ds_read_b64_tr_b16 v[136:137], v226 offset:2048
    ds_read_b64_tr_b16 v[138:139], v227 offset:2048
    ds_write_b64 v172, v[176:177]
    v_cvt_pk_bf16_f32 v67, v142, v143
    v_exp_f32 v146, v40
    v_exp_f32 v147, v41
    v_rcp_f32 v144, v144
    v_rcp_f32 v145, v145
    v_pk_add_f32 v[146:147], v[146:147], 1.0 op_sel_hi:[1,0]
    v_pk_mul_f32 v[144:145], v[144:145], v[38:39]
    ds_read_b128 v[152:155], v173 offset:4352
    ds_read_b128 v[156:159], v173 offset:4368
    v_xor_b32 v161, v160, v228
    v_cndmask_b32 v172, v241, v161, s[44:45]
    v_cvt_pk_bf16_f32 v170, v166, v167
    v_cvt_pk_bf16_f32 v171, v168, 1.0
    v_smfmac_f32_32x32x32_bf16 v[50:65], v[232:235], v[106:113], v236
    v_cvt_pk_bf16_f32 v68, v144, v145
    v_exp_f32 v140, v42
    v_exp_f32 v141, v43
    v_rcp_f32 v146, v146
    v_rcp_f32 v147, v147
    v_pk_add_f32 v[140:141], v[140:141], 1.0 op_sel_hi:[1,0]
    v_pk_mul_f32 v[146:147], v[146:147], v[40:41]
    v_dot2_f32_bf16 v169, v171, v171, -1.0
    v_dot2_f32_bf16 v169, v170, v170, v169
    ds_write_b64 v172, v[170:171]
    v_cvt_pk_bf16_f32 v69, v146, v147
    v_exp_f32 v142, v44
    v_exp_f32 v143, v45
    v_rcp_f32 v140, v140
    v_rcp_f32 v141, v141
    v_pk_add_f32 v[142:143], v[142:143], 1.0 op_sel_hi:[1,0]
    v_pk_mul_f32 v[140:141], v[140:141], v[42:43]
    s_waitcnt vmcnt(0)
    ds_read_b64_tr_b16 v[82:83], v220 offset:0
    ds_read_b64_tr_b16 v[84:85], v220 offset:512
    ds_read_b64_tr_b16 v[86:87], v220 offset:2048
    ds_read_b64_tr_b16 v[88:89], v220 offset:2560
    ds_read_b64_tr_b16 v[90:91], v221 offset:0
    ds_read_b64_tr_b16 v[92:93], v221 offset:512
    ds_read_b64_tr_b16 v[94:95], v221 offset:2048
    ds_read_b64_tr_b16 v[96:97], v221 offset:2560
    s_waitcnt lgkmcnt(15)
    v_cvt_pk_bf16_f32 v128, v169, v169
    v_permlane32_swap_b32 v126, v130
    v_permlane32_swap_b32 v127, v131
    v_cvt_pk_bf16_f32 v70, v140, v141
    v_exp_f32 v144, v46
    v_exp_f32 v145, v47
    v_rcp_f32 v142, v142
    v_rcp_f32 v143, v143
    v_pk_add_f32 v[144:145], v[144:145], 1.0 op_sel_hi:[1,0]
    v_pk_mul_f32 v[142:143], v[142:143], v[44:45]
    s_waitcnt lgkmcnt(9)
    v_mad_u32_u16 v152, v152, s30, v216
    v_mad_u32_u16 v154, v154, s30, v216
    v_mad_u32_u16 v156, v156, s30, v216
    v_mad_u32_u16 v158, v158, s30, v216
    v_cvt_pk_bf16_f32 v71, v142, v143
    v_exp_f32 v146, v48
    v_exp_f32 v147, v49
    v_rcp_f32 v144, v144
    v_rcp_f32 v145, v145
    v_pk_add_f32 v[146:147], v[146:147], 1.0 op_sel_hi:[1,0]
    v_pk_mul_f32 v[144:145], v[144:145], v[46:47]
    v_mfma_f32_32x32x16_bf16 v[2:17], v[132:135], v[66:69], v[2:17]
    v_cvt_pk_bf16_f32 v72, v144, v145
    v_exp_f32 v140, v50
    v_exp_f32 v141, v51
    v_rcp_f32 v146, v146
    v_rcp_f32 v147, v147
    v_pk_add_f32 v[140:141], v[140:141], 1.0 op_sel_hi:[1,0]
    v_pk_mul_f32 v[146:147], v[146:147], v[48:49]
    s_waitcnt lgkmcnt(0)
    buffer_load_dwordx4 v152, s[12:15], s34 offen offset:0 lds
    buffer_load_dwordx4 v154, s[12:15], s4 offen offset:1024 lds
    buffer_load_dwordx4 v156, s[12:15], s5 offen offset:2048 lds
    buffer_load_dwordx4 v158, s[12:15], s6 offen offset:3072 lds
    v_mfma_f32_32x32x16_bf16 v[34:49], v[126:129], v[116:119], 0
    v_cvt_pk_bf16_f32 v73, v146, v147
    v_exp_f32 v142, v52
    v_exp_f32 v143, v53
    v_rcp_f32 v140, v140
    v_rcp_f32 v141, v141
    v_pk_add_f32 v[142:143], v[142:143], 1.0 op_sel_hi:[1,0]
    v_pk_mul_f32 v[140:141], v[140:141], v[50:51]
    v_mfma_f32_32x32x16_bf16 v[2:17], v[136:139], v[70:73], v[2:17]
    v_cvt_pk_bf16_f32 v74, v140, v141
    v_exp_f32 v144, v54
    v_exp_f32 v145, v55
    v_rcp_f32 v142, v142
    v_rcp_f32 v143, v143
    v_pk_add_f32 v[144:145], v[144:145], 1.0 op_sel_hi:[1,0]
    v_pk_mul_f32 v[142:143], v[142:143], v[52:53]
    v_cvt_pk_bf16_f32 v75, v142, v143
    v_exp_f32 v146, v56
    v_exp_f32 v147, v57
    v_rcp_f32 v144, v144
    v_rcp_f32 v145, v145
    v_pk_add_f32 v[146:147], v[146:147], 1.0 op_sel_hi:[1,0]
    v_pk_mul_f32 v[144:145], v[144:145], v[54:55]
    v_smfmac_f32_32x32x32_bf16 v[34:49], v[232:235], v[82:89], v236
    v_cvt_pk_bf16_f32 v76, v144, v145
    v_exp_f32 v140, v58
    v_exp_f32 v141, v59
    v_rcp_f32 v146, v146
    v_rcp_f32 v147, v147
    v_pk_add_f32 v[140:141], v[140:141], 1.0 op_sel_hi:[1,0]
    v_pk_mul_f32 v[146:147], v[146:147], v[56:57]
    v_cvt_pk_bf16_f32 v77, v146, v147
    v_exp_f32 v142, v60
    v_exp_f32 v143, v61
    v_rcp_f32 v140, v140
    v_rcp_f32 v141, v141
    v_pk_add_f32 v[142:143], v[142:143], 1.0 op_sel_hi:[1,0]
    v_pk_mul_f32 v[140:141], v[140:141], v[58:59]
    v_cvt_pk_bf16_f32 v78, v140, v141
    v_exp_f32 v144, v62
    v_exp_f32 v145, v63
    v_rcp_f32 v142, v142
    v_rcp_f32 v143, v143
    v_pk_add_f32 v[144:145], v[144:145], 1.0 op_sel_hi:[1,0]
    v_pk_mul_f32 v[142:143], v[142:143], v[60:61]
    v_cvt_pk_bf16_f32 v79, v142, v143
    v_exp_f32 v146, v64
    v_exp_f32 v147, v65
    v_rcp_f32 v144, v144
    v_rcp_f32 v145, v145
    v_pk_add_f32 v[146:147], v[146:147], 1.0 op_sel_hi:[1,0]
    v_pk_mul_f32 v[144:145], v[144:145], v[62:63]
    s_cmp_lg_u32 s48, 0
    s_cbranch_scc1 K2S_LOOP
K2S_DRAIN:
    v_mfma_f32_32x32x16_bf16 v[18:33], v[132:135], v[74:77], v[18:33]
    v_rcp_f32 v146, v146
    v_rcp_f32 v147, v147
    v_cvt_pk_bf16_f32 v80, v144, v145
    v_mul_f32 v146, v146, v64
    v_mul_f32 v147, v147, v65
    v_cvt_pk_bf16_f32 v81, v146, v147
    s_mov_b32 s37, s36
    s_branch K2_LASTM
K2_EPOCH:
    v_mov_b32 v184, s69
    v_mov_b32 v185, s70
    v_mov_b32 v161, 4587520
    s_mov_b64 exec, 1
    buffer_store_dwordx2 v[184:185], v161, s[12:15], 0 offen
    s_mov_b64 exec, -1
    s_branch K2_EPOCH_RET
K2_OVER:
    s_mov_b32 s49, 16
    s_branch K2_AGAIN
K2_MORE:
    v_add_u32_sdwa v184, v149, v188 dst_sel:DWORD dst_unused:UNUSED_PAD src0_sel:DWORD src1_sel:WORD_1
    v_add_u32 v186, s49, v186
    v_min_u32 v186, v186, v184
    v_add_u32_sdwa v184, v149, v189 dst_sel:DWORD dst_unused:UNUSED_PAD src0_sel:DWORD src1_sel:WORD_1
    v_add_u32 v187, s49, v187
    v_min_u32 v187, v187, v184
K2_AGAIN:
    s_waitcnt vmcnt(0) lgkmcnt(0)
    s_barrier
    s_mov_b32 s50, 0
    s_cmp_lg_u32 s3, 0
    s_cbranch_scc1 K2_ROUND
    v_lshrrev_b32 v184, 1, v241
    ds_write_b32 v184, v176 offset:0
    v_mov_b32 v184, 512
    ds_write_b32 v184, v176
    s_branch K2_ROUND
.section .rodata,"a"
.p2align 6
.amdhsa_kernel gather_scatter__cheap_equivariant_egnn__graph_kernel
  .amdhsa_next_free_vgpr 256
  .amdhsa_next_free_sgpr 96
  .amdhsa_accum_offset 256
  .amdhsa_group_segment_fixed_size 0
  .amdhsa_kernarg_size 88
  .amdhsa_user_sgpr_count 2
  .amdhsa_user_sgpr_kernarg_segment_ptr 1
  .amdhsa_system_sgpr_workgroup_id_x 1
.end_amdhsa_kernel
```
